```python
import torch

def _softmax(x, axis=-1):
    return torch.softmax(x, dim=axis)
def _gelu(x):
    return torch.nn.functional.gelu(x, approximate="tanh")
def _silu(x):
    return torch.nn.functional.silu(x)
def _sigmoid(x):
    return torch.sigmoid(x)
def _layernorm(x, axis=-1, eps=1e-5):
    m = x.mean(dim=axis, keepdim=True)
    v = x.var(dim=axis, keepdim=True, unbiased=False)
    return (x - m) / torch.sqrt(v + eps)
def _scatter_add(tgt, idx, src, axis=0):
    return tgt.clone().index_add_(axis, idx, src)
def _segment_sum(src, seg, n):
    out = torch.zeros((n,) + src.shape[1:], dtype=src.dtype)
    return out.index_add_(0, seg, src)
def _pad(x, pw):
    flat = tuple(v for pair in reversed(pw) for v in pair)
    return torch.nn.functional.pad(x, flat)

kernel_name = 'concat_heads__spectral_fnet__sliding_block__prompt'

def setup_inputs():

    _w = (lambda a: (lambda t: t.to(torch.bfloat16) if t.is_floating_point() else t)(torch.as_tensor(a)))
    def _A_setup():
        B, S, D = 1, 2048, 512
        ns = torch.arange(S)[:, None] * torch.arange(S)[None, :]
        nd = torch.arange(D)[:, None] * torch.arange(D)[None, :]
        Ws_re = torch.cos(-2.0 * torch.pi * ns / S).to(float)
        Ws_im = torch.sin(-2.0 * torch.pi * ns / S).to(float)
        Wd_re = torch.cos(-2.0 * torch.pi * nd / D).to(float)
        Wd_im = torch.sin(-2.0 * torch.pi * nd / D).to(float)
        return {
            "x": _w((lambda *s: torch.randn(*s, dtype=torch.bfloat16) * 0.05)(B, S, D)),
            "dft_seq_re": _w(Ws_re),
            "dft_seq_im": _w(Ws_im),
            "dft_hid_re": _w(Wd_re),
            "dft_hid_im": _w(Wd_im),
        }
    _A_in = _A_setup()

    def _B_setup():
        B, S, D = 1, 2048, 512
        return {
            "x": _w((lambda *s: torch.randn(*s, dtype=torch.bfloat16) * 0.2)(B, S, D)),
            "wqkv": _w((lambda *s: torch.randn(*s, dtype=torch.bfloat16) * 0.8)(D, 3 * D)),
            "wo": _w((lambda *s: torch.randn(*s, dtype=torch.bfloat16) * 0.2)(D, D)),
        }
    _B_in = _B_setup()

    return {
        "A_x": _A_in["x"],
        "A_dft_seq_re": _A_in["dft_seq_re"],
        "A_dft_seq_im": _A_in["dft_seq_im"],
        "A_dft_hid_re": _A_in["dft_hid_re"],
        "A_dft_hid_im": _A_in["dft_hid_im"],
        "B_x": _B_in["x"],
        "B_wqkv": _B_in["wqkv"],
        "B_wo": _B_in["wo"],
    }

def reference(A_x, A_dft_seq_re, A_dft_seq_im, A_dft_hid_re, A_dft_hid_im, B_x, B_wqkv, B_wo):
    def _A_ref(x, dft_seq_re, dft_seq_im, dft_hid_re, dft_hid_im):
        a = torch.einsum("bsd,ed->bse", x, dft_hid_re)
        b = torch.einsum("bsd,ed->bse", x, dft_hid_im)
        y = torch.einsum("ts,bse->bte", dft_seq_re, a) - torch.einsum("ts,bse->bte", dft_seq_im, b)
        return y

    def _B_ref(x, wqkv, wo):
        B, S, D = x.shape
        H = 32; Dh = D // H; W = 256
        qkv = (lambda x, *d: x.permute(*d))((x @ wqkv).reshape(B, S, 3, H, Dh), 2, 0, 3, 1, 4)
        q, k, v = qkv[0], qkv[1], qkv[2]
        scores = torch.einsum("bhqd,bhkd->bhqk", q, k) * (Dh ** -0.5)
        idx = torch.arange(S)
        mask = (idx[:, None] - idx[None, :] >= 0) & (idx[:, None] - idx[None, :] < W)
        scores = torch.where(mask[None, None], scores, -1e9)
        p = _softmax(scores, axis=-1)
        o = torch.einsum("bhqk,bhkd->bhqd", p, v)
        return (lambda x, *d: x.permute(*d))(o, 0, 2, 1, 3).reshape(B, S, D) @ wo

    a = _A_ref(A_x, A_dft_seq_re, A_dft_seq_im, A_dft_hid_re, A_dft_hid_im)
    b = _B_ref(B_x, B_wqkv, B_wo)
    return torch.concatenate([a, b], axis=-1)
```

```asm
; @launch grid=(256,1,1) block=(512,1,1) lds=163840
.amdgcn_target "amdgcn-amd-amdhsa--gfx950"
.text
.globl concat_heads__spectral_fnet__sliding_block__prompt_kernel
.p2align 8
.type concat_heads__spectral_fnet__sliding_block__prompt_kernel,@function
concat_heads__spectral_fnet__sliding_block__prompt_kernel:
    s_cmp_ge_u32 s2, 256
    s_cbranch_scc1 L_end
    s_load_dwordx4 s[4:7], s[0:1], 40
    s_load_dwordx2 s[8:9], s[0:1], 80
    s_load_dwordx2 s[10:11], s[0:1], 0
    s_load_dwordx4 s[12:15], s[0:1], 56
    v_lshrrev_b32 v2, 6, v0
    v_and_b32 v1, 63, v0
    s_and_b32 s48, s2, 7
    s_lshr_b32 s49, s2, 3
    v_readfirstlane_b32 s52, v2
    s_lshr_b32 s50, s48, 2
    s_lshl_b32 s50, s50, 4
    s_and_b32 s55, s49, 15
    s_add_u32 s50, s50, s55
    s_and_b32 s51, s48, 3
    s_lshl_b32 s51, s51, 1
    s_lshr_b32 s55, s49, 4
    s_add_u32 s51, s51, s55
    s_xor_b32 s52, s52, 4
    s_setprio 1
    s_cmp_lt_u32 s52, 4
    s_cbranch_scc1 L_comp
    s_sub_u32 s56, s52, 4
    s_mul_i32 s53, s50, 1
    s_mul_i32 s55, s51, 2
    s_add_u32 s53, s53, s55
    s_and_b32 s53, s53, 3
    s_mul_i32 s53, s53, 2
    s_mul_i32 s55, s48, 1
    s_add_u32 s53, s53, s55
    s_lshl_b32 s57, s56, 4
    s_lshl_b32 s55, s50, 6
    s_add_u32 s55, s55, s57
    v_lshrrev_b32 v3, 3, v1
    v_add_u32 v9, s57, v3
    v_add_u32 v10, s55, v3
    v_lshrrev_b32 v11, 1, v3
    v_xor_b32 v11, v11, v1
    v_and_b32 v11, 7, v11
    v_lshlrev_b32 v11, 4, v11
    v_lshl_add_u32 v4, v10, 10, v11
    v_xor_b32 v5, 64, v4
    v_add_u32 v5, 8192, v5
    v_lshlrev_b32 v11, 1, v3
    v_and_b32 v11, 4, v11
    v_xor_b32 v11, v11, v1
    v_and_b32 v11, 7, v11
    v_lshlrev_b32 v11, 4, v11
    v_mul_u32_u24 v9, 3072, v9
    s_lshl_b32 s55, s51, 7
    v_add3_u32 v6, v9, v11, s55
    v_add_u32 v7, 24576, v6
    s_lshl_b32 s61, s56, 11
    s_waitcnt lgkmcnt(0)
    s_mov_b32 s16, s4
    s_mov_b32 s17, s5
    s_mov_b32 s18, 0x200000
    s_mov_b32 s19, 0x20000
    s_mov_b32 s20, s6
    s_mov_b32 s21, s7
    s_mov_b32 s22, 0x180000
    s_mov_b32 s23, 0x20000
    s_add_u32 s57, s53, 0
    s_and_b32 s57, s57, 7
    s_mul_i32 s58, s57, 196608
    s_lshl_b32 s57, s57, 7
    s_add_u32 m0, s61, 0
    s_add_u32 s58, s58, 1024
    buffer_load_dwordx4 v4, s[16:19], s57 offen  lds
    s_add_u32 m0, s61, 1024
    s_add_u32 s55, s58, 1024
    buffer_load_dwordx4 v5, s[16:19], s57 offen  lds
    s_add_u32 m0, s61, 65536
    s_nop 0
    buffer_load_dwordx4 v6, s[20:23], s58 offen  lds
    s_add_u32 m0, s61, 66560
    s_nop 0
    buffer_load_dwordx4 v7, s[20:23], s58 offen  lds
    s_add_u32 m0, s61, 73728
    s_nop 0
    buffer_load_dwordx4 v6, s[20:23], s55 offen  lds
    s_add_u32 m0, s61, 74752
    s_nop 0
    buffer_load_dwordx4 v7, s[20:23], s55 offen  lds
    s_load_dword s54, s[8:9], 0
    s_add_u32 s57, s53, 1
    s_and_b32 s57, s57, 7
    s_mul_i32 s58, s57, 196608
    s_lshl_b32 s57, s57, 7
    s_add_u32 m0, s61, 8192
    s_add_u32 s58, s58, 1024
    buffer_load_dwordx4 v4, s[16:19], s57 offen  lds
    s_add_u32 m0, s61, 9216
    s_add_u32 s55, s58, 1024
    buffer_load_dwordx4 v5, s[16:19], s57 offen  lds
    s_add_u32 m0, s61, 81920
    s_nop 0
    buffer_load_dwordx4 v6, s[20:23], s58 offen  lds
    s_add_u32 m0, s61, 82944
    s_nop 0
    buffer_load_dwordx4 v7, s[20:23], s58 offen  lds
    s_add_u32 m0, s61, 90112
    s_nop 0
    buffer_load_dwordx4 v6, s[20:23], s55 offen  lds
    s_add_u32 m0, s61, 91136
    s_nop 0
    buffer_load_dwordx4 v7, s[20:23], s55 offen  lds
    v_and_b32 v12, 15, v1
    v_lshrrev_b32 v13, 4, v1
    v_cvt_f32_u32 v14, v12
    v_mul_f32 v15, 0x3b800000, v14
    v_lshlrev_b32 v9, 6, v13
    s_lshr_b32 s59, s61, 9
    v_add_u32 v9, s59, v9
    v_cvt_f32_u32 v9, v9
    v_mul_f32 v9, v9, v15
    v_mul_f32 v11, 0x41800000, v15
    v_mov_b32 v10, v9
    v_cos_f32 v80, v10
    v_sin_f32 v84, v10
    v_add_f32 v10, v10, v11
    v_cos_f32 v81, v10
    v_sin_f32 v85, v10
    v_add_f32 v10, v10, v11
    v_cos_f32 v82, v10
    v_sin_f32 v86, v10
    v_add_f32 v10, v10, v11
    v_cos_f32 v83, v10
    v_sin_f32 v87, v10
    v_add_f32 v9, v9, v15
    v_cvt_pk_bf16_f32 v64, v80, v81
    v_cvt_pk_bf16_f32 v65, v82, v83
    v_cvt_pk_bf16_f32 v66, -v84, -v85
    v_cvt_pk_bf16_f32 v67, -v86, -v87
    v_mov_b32 v10, v9
    v_cos_f32 v80, v10
    v_sin_f32 v84, v10
    v_add_f32 v10, v10, v11
    v_cos_f32 v81, v10
    v_sin_f32 v85, v10
    v_add_f32 v10, v10, v11
    v_cos_f32 v82, v10
    v_sin_f32 v86, v10
    v_add_f32 v10, v10, v11
    v_cos_f32 v83, v10
    v_sin_f32 v87, v10
    v_add_f32 v9, v9, v15
    v_cvt_pk_bf16_f32 v68, v80, v81
    v_cvt_pk_bf16_f32 v69, v82, v83
    v_cvt_pk_bf16_f32 v70, -v84, -v85
    v_cvt_pk_bf16_f32 v71, -v86, -v87
    v_mov_b32 v10, v9
    v_cos_f32 v80, v10
    v_sin_f32 v84, v10
    v_add_f32 v10, v10, v11
    v_cos_f32 v81, v10
    v_sin_f32 v85, v10
    v_add_f32 v10, v10, v11
    v_cos_f32 v82, v10
    v_sin_f32 v86, v10
    v_add_f32 v10, v10, v11
    v_cos_f32 v83, v10
    v_sin_f32 v87, v10
    v_add_f32 v9, v9, v15
    v_cvt_pk_bf16_f32 v72, v80, v81
    v_cvt_pk_bf16_f32 v73, v82, v83
    v_cvt_pk_bf16_f32 v74, -v84, -v85
    v_cvt_pk_bf16_f32 v75, -v86, -v87
    v_mov_b32 v10, v9
    v_cos_f32 v80, v10
    v_sin_f32 v84, v10
    v_add_f32 v10, v10, v11
    v_cos_f32 v81, v10
    v_sin_f32 v85, v10
    v_add_f32 v10, v10, v11
    v_cos_f32 v82, v10
    v_sin_f32 v86, v10
    v_add_f32 v10, v10, v11
    v_cos_f32 v83, v10
    v_sin_f32 v87, v10
    v_add_f32 v9, v9, v15
    v_cvt_pk_bf16_f32 v76, v80, v81
    v_cvt_pk_bf16_f32 v77, v82, v83
    v_cvt_pk_bf16_f32 v78, -v84, -v85
    v_cvt_pk_bf16_f32 v79, -v86, -v87
    v_mul_f32 v15, 0x3d800000, v14
    v_lshlrev_b32 v9, 2, v13
    v_cvt_f32_u32 v9, v9
    v_mul_f32 v10, v9, v15
    v_cos_f32 v80, v10
    v_sin_f32 v81, v10
    v_add_f32 v10, v10, v15
    v_cvt_pk_bf16_f32 v16, v80, v81
    v_cvt_pk_bf16_f32 v20, -v81, v80
    v_cos_f32 v80, v10
    v_sin_f32 v81, v10
    v_add_f32 v10, v10, v15
    v_cvt_pk_bf16_f32 v17, v80, v81
    v_cvt_pk_bf16_f32 v21, -v81, v80
    v_cos_f32 v80, v10
    v_sin_f32 v81, v10
    v_add_f32 v10, v10, v15
    v_cvt_pk_bf16_f32 v18, v80, v81
    v_cvt_pk_bf16_f32 v22, -v81, v80
    v_cos_f32 v80, v10
    v_sin_f32 v81, v10
    v_add_f32 v10, v10, v15
    v_cvt_pk_bf16_f32 v19, v80, v81
    v_cvt_pk_bf16_f32 v23, -v81, v80
    s_mov_b32 s24, s10
    s_mov_b32 s25, s11
    s_mov_b32 s26, 0x200000
    s_mov_b32 s27, 0x20000
    v_bfe_u32 v9, v1, 1, 4
    v_lshlrev_b32 v9, 17, v9
    v_lshrrev_b32 v10, 5, v1
    v_lshl_add_u32 v9, v10, 13, v9
    v_and_b32 v10, 1, v1
    v_lshl_add_u32 v9, v10, 4, v9
    s_lshl_b32 s59, s61, 4
    s_lshl_b32 s60, s48, 10
    s_add_u32 s59, s59, s60
    s_lshl_b32 s60, s49, 5
    s_add_u32 s59, s59, s60
    v_add_u32 v8, s59, v9
    s_lshl_b32 s5, s48, 4
    s_and_b32 s59, s49, 15
    s_add_u32 s5, s5, s59
    s_mov_b32 s4, s5
    s_mov_b32 s6, 0
    s_cmp_lt_u32 s49, 16
    s_cbranch_scc1 L_k1done
    s_sub_u32 s4, 256, s5
    s_mov_b32 s6, 0x80000000
    s_cmp_lg_u32 s5, 0
    s_cbranch_scc1 L_k1done
    s_mov_b32 s4, 128
    s_mov_b32 s5, 128
    s_mov_b32 s6, 0
L_k1done:
    s_add_u32 s57, s53, 2
    s_and_b32 s57, s57, 7
    s_mul_i32 s58, s57, 196608
    s_lshl_b32 s57, s57, 7
    s_add_u32 m0, s61, 16384
    s_add_u32 s58, s58, 1024
    buffer_load_dwordx4 v4, s[16:19], s57 offen  lds
    s_add_u32 m0, s61, 17408
    s_add_u32 s55, s58, 1024
    buffer_load_dwordx4 v5, s[16:19], s57 offen  lds
    s_add_u32 m0, s61, 98304
    s_nop 0
    buffer_load_dwordx4 v6, s[20:23], s58 offen  lds
    s_add_u32 m0, s61, 99328
    s_nop 0
    buffer_load_dwordx4 v7, s[20:23], s58 offen  lds
    s_add_u32 m0, s61, 106496
    s_nop 0
    buffer_load_dwordx4 v6, s[20:23], s55 offen  lds
    s_add_u32 m0, s61, 107520
    s_nop 0
    buffer_load_dwordx4 v7, s[20:23], s55 offen  lds
    s_waitcnt vmcnt(12)
    s_barrier
    s_add_u32 s57, s53, 3
    s_and_b32 s57, s57, 7
    s_mul_i32 s58, s57, 196608
    s_lshl_b32 s57, s57, 7
    s_add_u32 m0, s61, 24576
    s_add_u32 s58, s58, 1024
    buffer_load_dwordx4 v4, s[16:19], s57 offen  lds
    s_add_u32 m0, s61, 25600
    s_add_u32 s55, s58, 1024
    buffer_load_dwordx4 v5, s[16:19], s57 offen  lds
    s_add_u32 m0, s61, 114688
    s_nop 0
    buffer_load_dwordx4 v6, s[20:23], s58 offen  lds
    s_add_u32 m0, s61, 115712
    s_nop 0
    buffer_load_dwordx4 v7, s[20:23], s58 offen  lds
    s_add_u32 m0, s61, 122880
    s_nop 0
    buffer_load_dwordx4 v6, s[20:23], s55 offen  lds
    s_add_u32 m0, s61, 123904
    s_nop 0
    buffer_load_dwordx4 v7, s[20:23], s55 offen  lds
    s_waitcnt vmcnt(12)
    s_barrier
    s_add_u32 s57, s53, 4
    s_and_b32 s57, s57, 7
    s_mul_i32 s58, s57, 196608
    s_lshl_b32 s57, s57, 7
    s_add_u32 m0, s61, 32768
    s_add_u32 s58, s58, 1024
    buffer_load_dwordx4 v4, s[16:19], s57 offen  lds
    s_add_u32 m0, s61, 33792
    s_add_u32 s55, s58, 1024
    buffer_load_dwordx4 v5, s[16:19], s57 offen  lds
    s_add_u32 m0, s61, 65536
    s_nop 0
    buffer_load_dwordx4 v6, s[20:23], s58 offen  lds
    s_add_u32 m0, s61, 66560
    s_nop 0
    buffer_load_dwordx4 v7, s[20:23], s58 offen  lds
    s_add_u32 m0, s61, 73728
    s_nop 0
    buffer_load_dwordx4 v6, s[20:23], s55 offen  lds
    s_add_u32 m0, s61, 74752
    s_nop 0
    buffer_load_dwordx4 v7, s[20:23], s55 offen  lds
    s_waitcnt vmcnt(12)
    s_barrier
    s_add_u32 s57, s53, 5
    s_and_b32 s57, s57, 7
    s_mul_i32 s58, s57, 196608
    s_lshl_b32 s57, s57, 7
    s_add_u32 m0, s61, 40960
    s_add_u32 s58, s58, 1024
    buffer_load_dwordx4 v4, s[16:19], s57 offen  lds
    s_add_u32 m0, s61, 41984
    s_add_u32 s55, s58, 1024
    buffer_load_dwordx4 v5, s[16:19], s57 offen  lds
    s_add_u32 m0, s61, 81920
    s_nop 0
    buffer_load_dwordx4 v6, s[20:23], s58 offen  lds
    s_add_u32 m0, s61, 82944
    s_nop 0
    buffer_load_dwordx4 v7, s[20:23], s58 offen  lds
    s_add_u32 m0, s61, 90112
    s_nop 0
    buffer_load_dwordx4 v6, s[20:23], s55 offen  lds
    s_add_u32 m0, s61, 91136
    s_nop 0
    buffer_load_dwordx4 v7, s[20:23], s55 offen  lds
    s_waitcnt vmcnt(12)
    s_barrier
    s_add_u32 s57, s53, 6
    s_and_b32 s57, s57, 7
    s_mul_i32 s58, s57, 196608
    s_lshl_b32 s57, s57, 7
    s_add_u32 m0, s61, 49152
    s_add_u32 s58, s58, 1024
    buffer_load_dwordx4 v4, s[16:19], s57 offen  lds
    s_add_u32 m0, s61, 50176
    s_add_u32 s55, s58, 1024
    buffer_load_dwordx4 v5, s[16:19], s57 offen  lds
    s_add_u32 m0, s61, 98304
    s_nop 0
    buffer_load_dwordx4 v6, s[20:23], s58 offen  lds
    s_add_u32 m0, s61, 99328
    s_nop 0
    buffer_load_dwordx4 v7, s[20:23], s58 offen  lds
    s_add_u32 m0, s61, 106496
    s_nop 0
    buffer_load_dwordx4 v6, s[20:23], s55 offen  lds
    s_add_u32 m0, s61, 107520
    s_nop 0
    buffer_load_dwordx4 v7, s[20:23], s55 offen  lds
    s_waitcnt vmcnt(12)
    s_barrier
    s_add_u32 s57, s53, 7
    s_and_b32 s57, s57, 7
    s_mul_i32 s58, s57, 196608
    s_lshl_b32 s57, s57, 7
    s_add_u32 m0, s61, 57344
    s_add_u32 s58, s58, 1024
    buffer_load_dwordx4 v4, s[16:19], s57 offen  lds
    s_add_u32 m0, s61, 58368
    s_add_u32 s55, s58, 1024
    buffer_load_dwordx4 v5, s[16:19], s57 offen  lds
    s_add_u32 m0, s61, 114688
    s_nop 0
    buffer_load_dwordx4 v6, s[20:23], s58 offen  lds
    s_add_u32 m0, s61, 115712
    s_nop 0
    buffer_load_dwordx4 v7, s[20:23], s58 offen  lds
    s_add_u32 m0, s61, 122880
    s_nop 0
    buffer_load_dwordx4 v6, s[20:23], s55 offen  lds
    s_add_u32 m0, s61, 123904
    s_nop 0
    buffer_load_dwordx4 v7, s[20:23], s55 offen  lds
    s_waitcnt vmcnt(12)
    s_barrier
    s_add_u32 s57, s53, 0
    s_and_b32 s57, s57, 7
    s_mul_i32 s58, s57, 196608
    s_add_u32 m0, s61, 65536
    s_nop 0
    buffer_load_dwordx4 v6, s[20:23], s58 offen lds
    s_add_u32 m0, s61, 66560
    s_nop 0
    buffer_load_dwordx4 v7, s[20:23], s58 offen lds
    s_add_u32 s57, s53, 1
    s_and_b32 s57, s57, 7
    s_mul_i32 s58, s57, 196608
    s_add_u32 m0, s61, 73728
    s_nop 0
    buffer_load_dwordx4 v6, s[20:23], s58 offen lds
    s_add_u32 m0, s61, 74752
    s_nop 0
    buffer_load_dwordx4 v7, s[20:23], s58 offen lds
    s_waitcnt vmcnt(10)
    s_barrier
    s_add_u32 s57, s53, 2
    s_and_b32 s57, s57, 7
    s_mul_i32 s58, s57, 196608
    s_add_u32 m0, s61, 81920
    s_nop 0
    buffer_load_dwordx4 v6, s[20:23], s58 offen lds
    s_add_u32 m0, s61, 82944
    s_nop 0
    buffer_load_dwordx4 v7, s[20:23], s58 offen lds
    s_add_u32 s57, s53, 3
    s_and_b32 s57, s57, 7
    s_mul_i32 s58, s57, 196608
    s_add_u32 m0, s61, 90112
    s_nop 0
    buffer_load_dwordx4 v6, s[20:23], s58 offen lds
    s_add_u32 m0, s61, 91136
    s_nop 0
    buffer_load_dwordx4 v7, s[20:23], s58 offen lds
    s_mov_b32 s36, s8
    s_mov_b32 s37, s9
    s_mov_b32 s38, 0xc00000
    s_mov_b32 s39, 0x20000
    s_mov_b32 s28, s12
    s_mov_b32 s29, s13
    s_mov_b32 s30, 0x80000
    s_mov_b32 s31, 0x20000
    s_mov_b32 s32, s14
    s_mov_b32 s33, s15
    s_mov_b32 s34, 0x400000
    s_mov_b32 s35, 0x20000
    s_lshl_b32 s59, s51, 18
    s_add_u32 s60, s59, 1048576
    s_add_u32 s40, s8, s60
    s_addc_u32 s41, s9, 0
    s_mov_b32 s42, 0x40000
    s_mov_b32 s43, 0x20000
    s_add_u32 s60, s59, 3145728
    s_add_u32 s44, s8, s60
    s_addc_u32 s45, s9, 0
    s_mov_b32 s46, 0x40000
    s_mov_b32 s47, 0x20000
    s_mov_b32 s96, 0xffff
    s_mov_b32 s97, 0xffff
    s_waitcnt lgkmcnt(0)
    s_mul_i32 s54, s54, 0x9E3779B1
    s_add_u32 s54, s54, 0x7F4A7C15
    s_waitcnt vmcnt(8)
    s_barrier
    s_add_u32 s57, s53, 4
    s_and_b32 s57, s57, 7
    s_mul_i32 s58, s57, 196608
    s_add_u32 m0, s61, 98304
    s_nop 0
    buffer_load_dwordx4 v6, s[20:23], s58 offen lds
    s_add_u32 m0, s61, 99328
    s_nop 0
    buffer_load_dwordx4 v7, s[20:23], s58 offen lds
    s_add_u32 s57, s53, 5
    s_and_b32 s57, s57, 7
    s_mul_i32 s58, s57, 196608
    s_add_u32 m0, s61, 106496
    s_nop 0
    buffer_load_dwordx4 v6, s[20:23], s58 offen lds
    s_add_u32 m0, s61, 107520
    s_nop 0
    buffer_load_dwordx4 v7, s[20:23], s58 offen lds
    v_bfe_u32 v9, v1, 2, 2
    v_and_b32 v10, 3, v1
    s_lshl_b32 s59, s61, 1
    s_add_u32 s59, s59, 147456
    v_lshl_add_u32 v11, v13, 2, v9
    v_lshlrev_b32 v11, 5, v11
    v_lshl_add_u32 v11, v10, 3, v11
    v_add_u32 v60, s59, v11
    s_lshr_b32 s60, s61, 11
    s_and_b32 s60, s60, 1
    v_xor_b32 v14, v12, v13
    v_xor_b32 v15, s60, v13
    v_lshl_or_b32 v14, v15, 4, v14
    v_lshlrev_b32 v14, 3, v14
    v_add_u32 v84, s59, v14
    v_xor_b32 v85, 32, v84
    v_xor_b32 v86, 64, v84
    v_xor_b32 v87, 96, v84
    v_lshrrev_b32 v11, 1, v9
    v_and_b32 v62, 1, v9
    v_lshl_or_b32 v63, v11, 3, v10
    v_lshl_or_b32 v63, v62, 2, v63
    s_lshr_b32 s60, s61, 9
    v_xor_b32 v63, s60, v63
    v_and_b32 v14, 1, v13
    v_xor_b32 v14, v14, v10
    v_lshl_or_b32 v14, v62, 2, v14
    v_lshl_or_b32 v63, v14, 4, v63
    v_lshlrev_b32 v63, 3, v63
    v_lshl_add_u32 v14, v13, 2, v11
    v_lshlrev_b32 v14, 10, v14
    v_add_u32 v14, v14, v63
    v_add_u32 v132, 147456, v14
    v_xor_b32 v133, 8, v132
    v_xor_b32 v134, 16, v132
    v_xor_b32 v135, 24, v132
    s_lshl_b32 s98, s61, 5
    s_lshl_b32 s60, s48, 11
    s_add_u32 s98, s98, s60
    s_lshl_b32 s60, s49, 6
    s_add_u32 s98, s98, s60
    s_add_u32 s98, s98, 8388608
    s_mov_b32 s3, 0x00ff00ff
    s_cmp_eq_u32 s61, 0
    s_cselect_b32 s99, 0x01ff01ff, s3
    s_mov_b32 s12, s98
    s_mov_b32 s13, s99
    s_mov_b32 s14, s3
    v_cvt_f32_u32 v14, v12
    v_mul_f32 v15, 0x3b000000, v14
    v_lshlrev_b32 v9, 3, v13
    v_cvt_f32_u32 v9, v9
    v_mul_f32 v10, v9, v15
    v_cos_f32 v24, v10
    v_sin_f32 v32, v10
    v_add_f32 v10, v10, v15
    v_cos_f32 v25, v10
    v_sin_f32 v33, v10
    v_add_f32 v10, v10, v15
    v_cos_f32 v26, v10
    v_sin_f32 v34, v10
    v_add_f32 v10, v10, v15
    v_cos_f32 v27, v10
    v_sin_f32 v35, v10
    v_add_f32 v10, v10, v15
    v_cos_f32 v28, v10
    v_sin_f32 v36, v10
    v_add_f32 v10, v10, v15
    v_cos_f32 v29, v10
    v_sin_f32 v37, v10
    v_add_f32 v10, v10, v15
    v_cos_f32 v30, v10
    v_sin_f32 v38, v10
    v_add_f32 v10, v10, v15
    v_cos_f32 v31, v10
    v_sin_f32 v39, v10
    v_add_f32 v10, v10, v15
    v_cvt_f32_u32 v14, v12
    v_and_b32 v9, 7, v12
    v_lshlrev_b32 v9, 8, v9
    v_add_u32 v9, s4, v9
    v_cvt_f32_u32 v9, v9
    v_mul_f32 v15, 0x3a000000, v9
    v_lshlrev_b32 v9, 1, v13
    v_cvt_f32_u32 v9, v9
    v_mul_f32 v10, v9, v15
    v_lshrrev_b32 v11, 3, v12
    v_mul_u32_u24 v11, 0x8000, v11
    v_lshl_or_b32 v11, v11, 16, v11
    v_cos_f32 v136, v10
    v_sin_f32 v137, v10
    v_add_f32 v10, v10, v15
    v_cvt_pk_bf16_f32 v56, v136, v137
    v_xor_b32 v57, v56, v11
    v_cos_f32 v136, v10
    v_sin_f32 v137, v10
    v_add_f32 v10, v10, v15
    v_cvt_pk_bf16_f32 v58, v136, v137
    v_xor_b32 v59, v58, v11
    s_waitcnt vmcnt(8)
    s_barrier
    s_add_u32 s57, s53, 6
    s_and_b32 s57, s57, 7
    s_mul_i32 s58, s57, 196608
    s_add_u32 m0, s61, 114688
    s_nop 0
    buffer_load_dwordx4 v6, s[20:23], s58 offen lds
    s_add_u32 m0, s61, 115712
    s_nop 0
    buffer_load_dwordx4 v7, s[20:23], s58 offen lds
    s_add_u32 s57, s53, 7
    s_and_b32 s57, s57, 7
    s_mul_i32 s58, s57, 196608
    s_add_u32 m0, s61, 122880
    s_nop 0
    buffer_load_dwordx4 v6, s[20:23], s58 offen lds
    s_add_u32 m0, s61, 123904
    s_nop 0
    buffer_load_dwordx4 v7, s[20:23], s58 offen lds
    v_and_b32 v9, 31, v1
    v_lshrrev_b32 v10, 5, v1
    v_lshlrev_b32 v10, 2, v10
    v_sub_u32 v9, v9, v10
    v_cmp_le_i32 s[64:65], 0, v9
    v_cmp_le_i32 s[66:67], 1, v9
    v_cmp_le_i32 s[68:69], 2, v9
    v_cmp_le_i32 s[70:71], 3, v9
    v_cmp_le_i32 s[72:73], 8, v9
    v_cmp_le_i32 s[74:75], 9, v9
    v_cmp_le_i32 s[76:77], 10, v9
    v_cmp_le_i32 s[78:79], 11, v9
    v_cmp_le_i32 s[80:81], 16, v9
    v_cmp_le_i32 s[82:83], 17, v9
    v_cmp_le_i32 s[84:85], 18, v9
    v_cmp_le_i32 s[86:87], 19, v9
    v_cmp_le_i32 s[88:89], 24, v9
    v_cmp_le_i32 s[90:91], 25, v9
    v_cmp_le_i32 s[92:93], 26, v9
    v_cmp_le_i32 s[94:95], 27, v9
    v_mov_b32 v10, 0xffff
    v_mov_b32 v11, 0xffff0000
    v_cndmask_b32 v240, 0, v10, s[64:65]
    v_cndmask_b32 v9, 0, v11, s[66:67]
    v_or_b32 v240, v240, v9
    v_cndmask_b32 v241, 0, v10, s[68:69]
    v_cndmask_b32 v9, 0, v11, s[70:71]
    v_or_b32 v241, v241, v9
    v_cndmask_b32 v242, 0, v10, s[72:73]
    v_cndmask_b32 v9, 0, v11, s[74:75]
    v_or_b32 v242, v242, v9
    v_cndmask_b32 v243, 0, v10, s[76:77]
    v_cndmask_b32 v9, 0, v11, s[78:79]
    v_or_b32 v243, v243, v9
    v_cndmask_b32 v244, 0, v10, s[80:81]
    v_cndmask_b32 v9, 0, v11, s[82:83]
    v_or_b32 v244, v244, v9
    v_cndmask_b32 v245, 0, v10, s[84:85]
    v_cndmask_b32 v9, 0, v11, s[86:87]
    v_or_b32 v245, v245, v9
    v_cndmask_b32 v246, 0, v10, s[88:89]
    v_cndmask_b32 v9, 0, v11, s[90:91]
    v_or_b32 v246, v246, v9
    v_cndmask_b32 v247, 0, v10, s[92:93]
    v_cndmask_b32 v9, 0, v11, s[94:95]
    v_or_b32 v247, v247, v9
    s_waitcnt vmcnt(8)
    s_barrier
    s_lshl_b32 s55, s61, 1
    s_add_u32 m0, s55, 147456
    s_mov_b32 s57, 16384
    buffer_load_dwordx4 v8, s[24:27], 0 offen nt lds
    s_add_u32 m0, s55, 148480
    s_nop 0
    buffer_load_dwordx4 v8, s[24:27], s57 offen nt lds
    v_cvt_f32_u32 v14, v12
    v_mul_f32 v15, 0x3d000000, v14
    v_lshlrev_b32 v9, 3, v13
    v_cvt_f32_u32 v9, v9
    v_mul_f32 v10, v9, v15
    v_cos_f32 v136, v10
    v_sin_f32 v137, v10
    v_add_f32 v10, v10, v15
    v_cvt_pk_bf16_f32 v40, v136, v137
    v_cvt_pk_bf16_f32 v44, -v137, v136
    v_cos_f32 v136, v10
    v_sin_f32 v137, v10
    v_add_f32 v10, v10, v15
    v_cvt_pk_bf16_f32 v48, v136, v137
    v_cvt_pk_bf16_f32 v52, -v137, v136
    v_cos_f32 v136, v10
    v_sin_f32 v137, v10
    v_add_f32 v10, v10, v15
    v_cvt_pk_bf16_f32 v41, v136, v137
    v_cvt_pk_bf16_f32 v45, -v137, v136
    v_cos_f32 v136, v10
    v_sin_f32 v137, v10
    v_add_f32 v10, v10, v15
    v_cvt_pk_bf16_f32 v49, v136, v137
    v_cvt_pk_bf16_f32 v53, -v137, v136
    v_cos_f32 v136, v10
    v_sin_f32 v137, v10
    v_add_f32 v10, v10, v15
    v_cvt_pk_bf16_f32 v42, v136, v137
    v_cvt_pk_bf16_f32 v46, -v137, v136
    v_cos_f32 v136, v10
    v_sin_f32 v137, v10
    v_add_f32 v10, v10, v15
    v_cvt_pk_bf16_f32 v50, v136, v137
    v_cvt_pk_bf16_f32 v54, -v137, v136
    v_cos_f32 v136, v10
    v_sin_f32 v137, v10
    v_add_f32 v10, v10, v15
    v_cvt_pk_bf16_f32 v43, v136, v137
    v_cvt_pk_bf16_f32 v47, -v137, v136
    v_cos_f32 v136, v10
    v_sin_f32 v137, v10
    v_add_f32 v10, v10, v15
    v_cvt_pk_bf16_f32 v51, v136, v137
    v_cvt_pk_bf16_f32 v55, -v137, v136
    s_waitcnt vmcnt(6)
    s_barrier
    v_mov_b32 v9, 0x3f803f80
    v_mov_b32 v224, v9
    v_mov_b32 v225, v9
    v_mov_b32 v226, v9
    v_mov_b32 v227, v9
    v_mov_b32 v228, v9
    v_mov_b32 v229, v9
    v_mov_b32 v230, v9
    v_mov_b32 v231, v9
    v_mov_b32 v232, v9
    v_mov_b32 v233, v9
    v_mov_b32 v234, v9
    v_mov_b32 v235, v9
    v_mov_b32 v236, v9
    v_mov_b32 v237, v9
    v_mov_b32 v238, v9
    v_mov_b32 v239, v9
    s_and_b32 s7, s52, 3
    s_lshr_b32 s10, s52, 2
    s_lshl_b32 s56, s7, 10
    v_lshlrev_b32 v13, 4, v1
    v_add_u32 v5, s56, v13
    s_lshl_b32 s63, s50, 1
    s_add_u32 s63, s63, s10
    s_lshl_b32 s62, s63, 12
    s_sub_u32 s62, s62, 32768
    s_lshl_b32 s55, s10, 12
    s_add_u32 s55, s55, s56
    s_lshr_b32 s57, s52, 1
    s_lshl_b32 s57, s57, 13
    s_and_b32 s59, s52, 1
    s_lshl_b32 s59, s59, 10
    s_add_u32 s57, s57, s59
    s_add_u32 s57, s57, 69632
    v_add_u32 v9, s57, v13
    v_add_u32 v10, s55, v13
    v_add_u32 v10, 131072, v10
    s_lshl_b32 s57, s50, 13
    s_lshl_b32 s3, s7, 13
    s_add_u32 s57, s57, s3
    s_sub_u32 s57, s57, 32768
    v_add_u32 v12, s57, v13
    s_mul_i32 s59, s10, 110592
    s_add_u32 s59, s59, 28672
    s_add_u32 s59, s59, s56
    v_lshrrev_b32 v13, 5, v1
    v_and_b32 v14, 15, v1
    v_lshlrev_b32 v14, 4, v14
    v_lshl_add_u32 v14, v13, 8, v14
    v_add_u32 v7, s59, v14
    v_add_u32 v6, s55, v14
    v_add_u32 v8, 139264, v6
    v_bfe_u32 v4, v1, 4, 1
    v_lshl_add_u32 v4, v4, 14, v14
    v_lshrrev_b32 v13, 3, v1
    v_lshrrev_b32 v11, 4, v1
    v_lshlrev_b32 v11, 1, v11
    v_xor_b32 v11, v11, v1
    v_and_b32 v11, 7, v11
    v_lshlrev_b32 v11, 4, v11
    v_lshl_add_u32 v11, v13, 10, v11
    s_lshl_b32 s55, s52, 16
    s_lshr_b32 s56, s49, 2
    s_lshl_b32 s56, s56, 7
    s_add_u32 s55, s55, s56
    v_add_u32 v11, s55, v11
    s_lshl_b32 s11, s52, 13
    s_add_u32 s11, s11, 65536
    s_lshl_b32 s98, s51, 5
    s_add_u32 s98, s98, s50
    s_add_u32 s98, s98, s7
    s_lshl_b32 s98, s98, 8
    s_add_u32 s98, s98, 130048
    s_lshl_b32 s53, s63, 15
    s_lshl_b32 s57, s51, 2
    s_add_u32 s57, s57, s7
    s_lshl_b32 s59, s57, 9
    s_add_u32 s53, s53, s59
    s_add_u32 s53, s53, 5242880
    s_lshl_b32 s55, s63, 5
    s_add_u32 s55, s55, s57
    s_lshl_b32 s55, s55, 4
    s_add_u32 s99, s55, 196608
    v_lshlrev_b32 v3, 6, v1
    v_and_b32 v15, 15, v1
    v_lshlrev_b32 v15, 18, v15
    v_lshrrev_b32 v13, 4, v1
    v_lshl_add_u32 v15, v13, 4, v15
    v_mov_b32 v13, 0
    v_mov_b32 v14, 32768
    s_waitcnt vmcnt(2)
    s_barrier
    s_waitcnt vmcnt(0)
    ds_read_b64_tr_b16 v[88:89], v60 offset:0
    ds_read_b64_tr_b16 v[90:91], v60 offset:512
    ds_read_b64_tr_b16 v[92:93], v60 offset:1024
    ds_read_b64_tr_b16 v[94:95], v60 offset:1536
    s_waitcnt lgkmcnt(3)
    v_mfma_f32_16x16x16_bf16 v[96:99], v[88:89], v[64:65], 0
    v_mfma_f32_16x16x16_bf16 v[100:103], v[88:89], v[66:67], 0
    s_waitcnt lgkmcnt(2)
    v_mfma_f32_16x16x16_bf16 v[104:107], v[90:91], v[68:69], 0
    v_mfma_f32_16x16x16_bf16 v[108:111], v[90:91], v[70:71], 0
    s_waitcnt lgkmcnt(1)
    v_mfma_f32_16x16x16_bf16 v[112:115], v[92:93], v[72:73], 0
    v_mfma_f32_16x16x16_bf16 v[116:119], v[92:93], v[74:75], 0
    s_waitcnt lgkmcnt(0)
    v_mfma_f32_16x16x16_bf16 v[120:123], v[94:95], v[76:77], 0
    v_mfma_f32_16x16x16_bf16 v[124:127], v[94:95], v[78:79], 0
    s_nop 1
    v_cvt_pk_bf16_f32 v96, v96, v97
    v_cvt_pk_bf16_f32 v97, v98, v99
    ds_write_b64 v84, v[96:97] offset:0
    v_cvt_pk_bf16_f32 v100, v100, v101
    v_cvt_pk_bf16_f32 v101, v102, v103
    ds_write_b64 v85, v[100:101] offset:512
    v_cvt_pk_bf16_f32 v104, v104, v105
    v_cvt_pk_bf16_f32 v105, v106, v107
    ds_write_b64 v86, v[104:105] offset:1024
    v_cvt_pk_bf16_f32 v108, v108, v109
    v_cvt_pk_bf16_f32 v109, v110, v111
    ds_write_b64 v87, v[108:109] offset:1536
    v_cvt_pk_bf16_f32 v112, v112, v113
    v_cvt_pk_bf16_f32 v113, v114, v115
    ds_write_b64 v84, v[112:113] offset:2048
    v_cvt_pk_bf16_f32 v116, v116, v117
    v_cvt_pk_bf16_f32 v117, v118, v119
    ds_write_b64 v85, v[116:117] offset:2560
    v_cvt_pk_bf16_f32 v120, v120, v121
    v_cvt_pk_bf16_f32 v121, v122, v123
    ds_write_b64 v86, v[120:121] offset:3072
    v_cvt_pk_bf16_f32 v124, v124, v125
    v_cvt_pk_bf16_f32 v125, v126, v127
    ds_write_b64 v87, v[124:125] offset:3584
    s_waitcnt lgkmcnt(0)
    s_setprio 1
    s_barrier
    s_branch L_attn
L_comp:
    s_cmp_lg_u32 s52, 0
    s_cbranch_scc1 L_nopf
    s_getpc_b64 s[56:57]
L_pc:
    s_lshl_b32 s55, s49, 10
    s_add_u32 s56, s56, s55
    s_addc_u32 s57, s57, 0
    s_sub_u32 s56, s56, L_pc-concat_heads__spectral_fnet__sliding_block__prompt_kernel
    s_subb_u32 s57, s57, 0
    v_lshlrev_b32 v4, 7, v1
    v_mov_b32 v5, s57
    v_add_co_u32 v4, vcc, s56, v4
    s_nop 1
    v_addc_co_u32 v5, vcc, 0, v5, vcc
    s_cmp_ge_u32 s55, L_codeend-concat_heads__spectral_fnet__sliding_block__prompt_kernel
    s_cbranch_scc1 L_nopf
    s_mov_b64 exec, 0xff
    global_load_dword v254, v[4:5], off
    s_mov_b64 exec, -1
L_nopf:
    s_waitcnt lgkmcnt(0)
    s_cmp_lg_u32 s52, 2
    s_cbranch_scc1 L_notlb
    v_lshlrev_b32 v4, 21, v1
    s_lshl_b32 s55, s2, 7
    v_add_u32 v4, s55, v4
    s_mov_b32 exec_lo, 0x3f
    s_mov_b32 exec_hi, 0x0
    global_load_dword v254, v4, s[8:9]
    s_mov_b32 exec_lo, 0x3
    s_mov_b32 exec_hi, 0x0
    global_load_dword v254, v4, s[14:15]
    s_mov_b32 exec_lo, 0x1
    s_mov_b32 exec_hi, 0x0
    global_load_dword v254, v4, s[10:11]
    s_mov_b64 exec, -1
L_notlb:
    s_cmp_lg_u32 s52, 1
    s_cbranch_scc1 L_nomp
    v_and_b32 v4, 15, v1
    s_lshl_b32 s55, s2, 4
    v_add_u32 v4, s55, v4
    v_lshlrev_b32 v5, 7, v4
    v_lshrrev_b32 v6, 3, v4
    v_mul_u32_u24 v6, 3072, v6
    v_and_b32 v4, 7, v4
    v_lshl_add_u32 v6, v4, 7, v6
    s_mov_b64 exec, 0xffff
    global_load_dword v254, v5, s[12:13]
    global_load_dword v254, v6, s[6:7]
    s_mov_b64 exec, -1
L_nomp:
    s_and_b32 s4, s52, 1
    s_lshr_b32 s5, s52, 1
    v_and_b32 v9, 31, v1
    v_lshrrev_b32 v10, 5, v1
    v_lshrrev_b32 v11, 1, v9
    v_xor_b32 v11, v11, v10
    v_and_b32 v11, 7, v11
    v_lshlrev_b32 v11, 4, v11
    s_lshl_b32 s55, s4, 12
    v_lshl_add_u32 v120, v9, 7, v11
    v_add_u32 v120, s55, v120
    v_xor_b32 v121, 32, v120
    v_xor_b32 v122, 64, v120
    v_xor_b32 v123, 96, v120
    v_bfe_u32 v9, v1, 2, 2
    v_and_b32 v10, 3, v1
    v_lshrrev_b32 v11, 4, v1
    v_lshrrev_b32 v12, 1, v11
    v_lshl_add_u32 v12, v12, 3, v9
    v_lshlrev_b32 v12, 7, v12
    v_and_b32 v13, 1, v11
    v_lshlrev_b32 v13, 1, v13
    v_lshrrev_b32 v14, 1, v10
    v_add_u32 v13, v13, v14
    s_lshl_b32 s55, s5, 2
    v_add_u32 v13, s55, v13
    v_lshlrev_b32 v14, 1, v9
    v_and_b32 v14, 4, v14
    v_xor_b32 v13, v13, v14
    v_lshl_add_u32 v12, v13, 4, v12
    v_and_b32 v13, 1, v10
    v_lshl_add_u32 v12, v13, 3, v12
    v_add_u32 v124, 65536, v12
    s_load_dword s54, s[8:9], 0
    s_mov_b32 s36, s8
    s_mov_b32 s37, s9
    s_mov_b32 s38, 0xc00000
    s_mov_b32 s39, 0x20000
    s_mov_b32 s28, s12
    s_mov_b32 s29, s13
    s_mov_b32 s30, 0x80000
    s_mov_b32 s31, 0x20000
    s_mov_b32 s32, s14
    s_mov_b32 s33, s15
    s_mov_b32 s34, 0x400000
    s_mov_b32 s35, 0x20000
    s_lshl_b32 s59, s51, 18
    s_add_u32 s60, s59, 1048576
    s_add_u32 s40, s8, s60
    s_addc_u32 s41, s9, 0
    s_mov_b32 s42, 0x40000
    s_mov_b32 s43, 0x20000
    s_add_u32 s60, s59, 3145728
    s_add_u32 s44, s8, s60
    s_addc_u32 s45, s9, 0
    s_mov_b32 s46, 0x40000
    s_mov_b32 s47, 0x20000
    s_mov_b32 s96, 0xffff
    s_mov_b32 s97, 0xffff
    s_waitcnt lgkmcnt(0)
    s_mul_i32 s54, s54, 0x9E3779B1
    s_add_u32 s54, s54, 0x7F4A7C15
    v_and_b32 v9, 31, v1
    v_lshrrev_b32 v10, 5, v1
    v_lshlrev_b32 v10, 2, v10
    v_sub_u32 v9, v9, v10
    v_cmp_le_i32 s[64:65], 0, v9
    v_cmp_le_i32 s[66:67], 1, v9
    v_cmp_le_i32 s[68:69], 2, v9
    v_cmp_le_i32 s[70:71], 3, v9
    v_cmp_le_i32 s[72:73], 8, v9
    v_cmp_le_i32 s[74:75], 9, v9
    v_cmp_le_i32 s[76:77], 10, v9
    v_cmp_le_i32 s[78:79], 11, v9
    v_cmp_le_i32 s[80:81], 16, v9
    v_cmp_le_i32 s[82:83], 17, v9
    v_cmp_le_i32 s[84:85], 18, v9
    v_cmp_le_i32 s[86:87], 19, v9
    v_cmp_le_i32 s[88:89], 24, v9
    v_cmp_le_i32 s[90:91], 25, v9
    v_cmp_le_i32 s[92:93], 26, v9
    v_cmp_le_i32 s[94:95], 27, v9
    v_mov_b32 v10, 0xffff
    v_mov_b32 v11, 0xffff0000
    v_cndmask_b32 v240, 0, v10, s[64:65]
    v_cndmask_b32 v9, 0, v11, s[66:67]
    v_or_b32 v240, v240, v9
    v_cndmask_b32 v241, 0, v10, s[68:69]
    v_cndmask_b32 v9, 0, v11, s[70:71]
    v_or_b32 v241, v241, v9
    v_cndmask_b32 v242, 0, v10, s[72:73]
    v_cndmask_b32 v9, 0, v11, s[74:75]
    v_or_b32 v242, v242, v9
    v_cndmask_b32 v243, 0, v10, s[76:77]
    v_cndmask_b32 v9, 0, v11, s[78:79]
    v_or_b32 v243, v243, v9
    v_cndmask_b32 v244, 0, v10, s[80:81]
    v_cndmask_b32 v9, 0, v11, s[82:83]
    v_or_b32 v244, v244, v9
    v_cndmask_b32 v245, 0, v10, s[84:85]
    v_cndmask_b32 v9, 0, v11, s[86:87]
    v_or_b32 v245, v245, v9
    v_cndmask_b32 v246, 0, v10, s[88:89]
    v_cndmask_b32 v9, 0, v11, s[90:91]
    v_or_b32 v246, v246, v9
    v_cndmask_b32 v247, 0, v10, s[92:93]
    v_cndmask_b32 v9, 0, v11, s[94:95]
    v_or_b32 v247, v247, v9
    v_mov_b32 v9, 0x3f803f80
    v_mov_b32 v224, v9
    v_mov_b32 v225, v9
    v_mov_b32 v226, v9
    v_mov_b32 v227, v9
    v_mov_b32 v228, v9
    v_mov_b32 v229, v9
    v_mov_b32 v230, v9
    v_mov_b32 v231, v9
    v_mov_b32 v232, v9
    v_mov_b32 v233, v9
    v_mov_b32 v234, v9
    v_mov_b32 v235, v9
    v_mov_b32 v236, v9
    v_mov_b32 v237, v9
    v_mov_b32 v238, v9
    v_mov_b32 v239, v9
    s_lshl_b32 s55, s4, 12
    s_lshl_b32 s56, s5, 11
    s_add_u32 s55, s55, s56
    v_lshlrev_b32 v13, 4, v1
    v_add_u32 v13, s55, v13
    v_add_u32 v127, 131072, v13
    s_lshl_b32 s56, s50, 13
    v_add_u32 v125, s56, v13
    v_bfe_u32 v13, v1, 4, 1
    v_lshlrev_b32 v13, 10, v13
    v_lshrrev_b32 v14, 5, v1
    v_lshl_add_u32 v13, v14, 8, v13
    v_and_b32 v14, 15, v1
    v_lshl_add_u32 v13, v14, 4, v13
    v_add_u32 v13, s55, v13
    v_add_u32 v128, 139264, v13
    v_add_u32 v126, s56, v13
    s_lshl_b32 s15, s51, 5
    s_add_u32 s15, s15, s50
    s_lshl_b32 s15, s15, 2
    s_add_u32 s15, s15, s52
    s_lshl_b32 s15, s15, 6
    s_add_u32 s15, s15, 65536
    s_and_b32 s7, s52, 3
    s_lshr_b32 s10, s52, 2
    s_lshl_b32 s56, s7, 10
    v_lshlrev_b32 v13, 4, v1
    v_add_u32 v5, s56, v13
    s_lshl_b32 s63, s50, 1
    s_add_u32 s63, s63, s10
    s_lshl_b32 s62, s63, 12
    s_sub_u32 s62, s62, 32768
    s_lshl_b32 s55, s10, 12
    s_add_u32 s55, s55, s56
    s_lshr_b32 s57, s52, 1
    s_lshl_b32 s57, s57, 13
    s_and_b32 s59, s52, 1
    s_lshl_b32 s59, s59, 10
    s_add_u32 s57, s57, s59
    s_add_u32 s57, s57, 69632
    v_add_u32 v9, s57, v13
    v_add_u32 v10, s55, v13
    v_add_u32 v10, 131072, v10
    s_lshl_b32 s57, s50, 13
    s_lshl_b32 s3, s7, 13
    s_add_u32 s57, s57, s3
    s_sub_u32 s57, s57, 32768
    v_add_u32 v12, s57, v13
    s_mul_i32 s59, s10, 110592
    s_add_u32 s59, s59, 28672
    s_add_u32 s59, s59, s56
    v_lshrrev_b32 v13, 5, v1
    v_and_b32 v14, 15, v1
    v_lshlrev_b32 v14, 4, v14
    v_lshl_add_u32 v14, v13, 8, v14
    v_add_u32 v7, s59, v14
    v_add_u32 v6, s55, v14
    v_add_u32 v8, 139264, v6
    v_bfe_u32 v4, v1, 4, 1
    v_lshl_add_u32 v4, v4, 14, v14
    v_lshrrev_b32 v13, 3, v1
    v_lshrrev_b32 v11, 4, v1
    v_lshlrev_b32 v11, 1, v11
    v_xor_b32 v11, v11, v1
    v_and_b32 v11, 7, v11
    v_lshlrev_b32 v11, 4, v11
    v_lshl_add_u32 v11, v13, 10, v11
    s_lshl_b32 s55, s52, 16
    s_lshr_b32 s56, s49, 2
    s_lshl_b32 s56, s56, 7
    s_add_u32 s55, s55, s56
    v_add_u32 v11, s55, v11
    s_lshl_b32 s11, s52, 13
    s_add_u32 s11, s11, 65536
    s_lshl_b32 s98, s51, 5
    s_add_u32 s98, s98, s50
    s_add_u32 s98, s98, s7
    s_lshl_b32 s98, s98, 8
    s_add_u32 s98, s98, 130048
    s_lshl_b32 s53, s63, 15
    s_lshl_b32 s57, s51, 2
    s_add_u32 s57, s57, s7
    s_lshl_b32 s59, s57, 9
    s_add_u32 s53, s53, s59
    s_add_u32 s53, s53, 5242880
    s_lshl_b32 s55, s63, 5
    s_add_u32 s55, s55, s57
    s_lshl_b32 s55, s55, 4
    s_add_u32 s99, s55, 196608
    v_lshlrev_b32 v3, 6, v1
    v_and_b32 v15, 15, v1
    v_lshlrev_b32 v15, 18, v15
    v_lshrrev_b32 v13, 4, v1
    v_lshl_add_u32 v15, v13, 4, v15
    v_mov_b32 v13, 0
    v_mov_b32 v14, 32768
    s_mov_b32 s59, 0x3eb8aa3b
    s_barrier
    ds_read_b128 v[64:67], v120 offset:0
    ds_read_b64_tr_b16 v[68:69], v124 offset:0
    ds_read_b64_tr_b16 v[70:71], v124 offset:512
    ds_read_b64_tr_b16 v[72:73], v124 offset:8192
    ds_read_b64_tr_b16 v[74:75], v124 offset:8704
    ds_read_b128 v[76:79], v121 offset:0
    ds_read_b64_tr_b16 v[80:81], v124 offset:2048
    ds_read_b64_tr_b16 v[82:83], v124 offset:2560
    ds_read_b64_tr_b16 v[84:85], v124 offset:10240
    ds_read_b64_tr_b16 v[86:87], v124 offset:10752
    ds_read_b128 v[88:91], v122 offset:0
    ds_read_b64_tr_b16 v[92:93], v124 offset:4096
    ds_read_b64_tr_b16 v[94:95], v124 offset:4608
    ds_read_b64_tr_b16 v[96:97], v124 offset:12288
    ds_read_b64_tr_b16 v[98:99], v124 offset:12800
    s_waitcnt lgkmcnt(12)
    v_mfma_f32_32x32x16_bf16 v[16:31], v[68:71], v[64:67], 0
    s_waitcnt lgkmcnt(10)
    v_mfma_f32_32x32x16_bf16 v[32:47], v[64:67], v[72:75], 0
    ds_read_b128 v[100:103], v123 offset:0
    ds_read_b64_tr_b16 v[104:105], v124 offset:6144
    ds_read_b64_tr_b16 v[106:107], v124 offset:6656
    ds_read_b64_tr_b16 v[108:109], v124 offset:14336
    ds_read_b64_tr_b16 v[110:111], v124 offset:14848
    s_waitcnt lgkmcnt(12)
    v_mfma_f32_32x32x16_bf16 v[16:31], v[80:83], v[76:79], v[16:31]
    s_waitcnt lgkmcnt(10)
    v_mfma_f32_32x32x16_bf16 v[32:47], v[76:79], v[84:87], v[32:47]
    s_waitcnt lgkmcnt(7)
    v_mfma_f32_32x32x16_bf16 v[16:31], v[92:95], v[88:91], v[16:31]
    s_waitcnt lgkmcnt(5)
    v_mfma_f32_32x32x16_bf16 v[32:47], v[88:91], v[96:99], v[32:47]
    s_waitcnt lgkmcnt(2)
    v_mfma_f32_32x32x16_bf16 v[16:31], v[104:107], v[100:103], v[16:31]
    s_waitcnt lgkmcnt(0)
    v_mfma_f32_32x32x16_bf16 v[32:47], v[100:103], v[108:111], v[32:47]
    s_barrier
    ds_read_b128 v[64:67], v120 offset:8192
    ds_read_b64_tr_b16 v[68:69], v124 offset:16384
    ds_read_b64_tr_b16 v[70:71], v124 offset:16896
    ds_read_b64_tr_b16 v[72:73], v124 offset:24576
    ds_read_b64_tr_b16 v[74:75], v124 offset:25088
    ds_read_b128 v[76:79], v121 offset:8192
    ds_read_b64_tr_b16 v[80:81], v124 offset:18432
    ds_read_b64_tr_b16 v[82:83], v124 offset:18944
    ds_read_b64_tr_b16 v[84:85], v124 offset:26624
    ds_read_b64_tr_b16 v[86:87], v124 offset:27136
    ds_read_b128 v[88:91], v122 offset:8192
    ds_read_b64_tr_b16 v[92:93], v124 offset:20480
    ds_read_b64_tr_b16 v[94:95], v124 offset:20992
    ds_read_b64_tr_b16 v[96:97], v124 offset:28672
    ds_read_b64_tr_b16 v[98:99], v124 offset:29184
    s_waitcnt lgkmcnt(12)
    v_mfma_f32_32x32x16_bf16 v[16:31], v[68:71], v[64:67], v[16:31]
    s_waitcnt lgkmcnt(10)
    v_mfma_f32_32x32x16_bf16 v[32:47], v[64:67], v[72:75], v[32:47]
    ds_read_b128 v[100:103], v123 offset:8192
    ds_read_b64_tr_b16 v[104:105], v124 offset:22528
    ds_read_b64_tr_b16 v[106:107], v124 offset:23040
    ds_read_b64_tr_b16 v[108:109], v124 offset:30720
    ds_read_b64_tr_b16 v[110:111], v124 offset:31232
    s_waitcnt lgkmcnt(12)
    v_mfma_f32_32x32x16_bf16 v[16:31], v[80:83], v[76:79], v[16:31]
    s_waitcnt lgkmcnt(10)
    v_mfma_f32_32x32x16_bf16 v[32:47], v[76:79], v[84:87], v[32:47]
    s_waitcnt lgkmcnt(7)
    v_mfma_f32_32x32x16_bf16 v[16:31], v[92:95], v[88:91], v[16:31]
    s_waitcnt lgkmcnt(5)
    v_mfma_f32_32x32x16_bf16 v[32:47], v[88:91], v[96:99], v[32:47]
    s_waitcnt lgkmcnt(2)
    v_mfma_f32_32x32x16_bf16 v[16:31], v[104:107], v[100:103], v[16:31]
    s_waitcnt lgkmcnt(0)
    v_mfma_f32_32x32x16_bf16 v[32:47], v[100:103], v[108:111], v[32:47]
    s_barrier
    ds_read_b128 v[64:67], v120 offset:16384
    ds_read_b64_tr_b16 v[68:69], v124 offset:32768
    ds_read_b64_tr_b16 v[70:71], v124 offset:33280
    ds_read_b64_tr_b16 v[72:73], v124 offset:40960
    ds_read_b64_tr_b16 v[74:75], v124 offset:41472
    ds_read_b128 v[76:79], v121 offset:16384
    ds_read_b64_tr_b16 v[80:81], v124 offset:34816
    ds_read_b64_tr_b16 v[82:83], v124 offset:35328
    ds_read_b64_tr_b16 v[84:85], v124 offset:43008
    ds_read_b64_tr_b16 v[86:87], v124 offset:43520
    ds_read_b128 v[88:91], v122 offset:16384
    ds_read_b64_tr_b16 v[92:93], v124 offset:36864
    ds_read_b64_tr_b16 v[94:95], v124 offset:37376
    ds_read_b64_tr_b16 v[96:97], v124 offset:45056
    ds_read_b64_tr_b16 v[98:99], v124 offset:45568
    s_waitcnt lgkmcnt(12)
    v_mfma_f32_32x32x16_bf16 v[16:31], v[68:71], v[64:67], v[16:31]
    s_waitcnt lgkmcnt(10)
    v_mfma_f32_32x32x16_bf16 v[32:47], v[64:67], v[72:75], v[32:47]
    ds_read_b128 v[100:103], v123 offset:16384
    ds_read_b64_tr_b16 v[104:105], v124 offset:38912
    ds_read_b64_tr_b16 v[106:107], v124 offset:39424
    ds_read_b64_tr_b16 v[108:109], v124 offset:47104
    ds_read_b64_tr_b16 v[110:111], v124 offset:47616
    s_waitcnt lgkmcnt(12)
    v_mfma_f32_32x32x16_bf16 v[16:31], v[80:83], v[76:79], v[16:31]
    s_waitcnt lgkmcnt(10)
    v_mfma_f32_32x32x16_bf16 v[32:47], v[76:79], v[84:87], v[32:47]
    s_waitcnt lgkmcnt(7)
    v_mfma_f32_32x32x16_bf16 v[16:31], v[92:95], v[88:91], v[16:31]
    s_waitcnt lgkmcnt(5)
    v_mfma_f32_32x32x16_bf16 v[32:47], v[88:91], v[96:99], v[32:47]
    s_waitcnt lgkmcnt(2)
    v_mfma_f32_32x32x16_bf16 v[16:31], v[104:107], v[100:103], v[16:31]
    s_waitcnt lgkmcnt(0)
    v_mfma_f32_32x32x16_bf16 v[32:47], v[100:103], v[108:111], v[32:47]
    s_barrier
    ds_read_b128 v[64:67], v120 offset:24576
    ds_read_b64_tr_b16 v[68:69], v124 offset:49152
    ds_read_b64_tr_b16 v[70:71], v124 offset:49664
    ds_read_b64_tr_b16 v[72:73], v124 offset:57344
    ds_read_b64_tr_b16 v[74:75], v124 offset:57856
    ds_read_b128 v[76:79], v121 offset:24576
    ds_read_b64_tr_b16 v[80:81], v124 offset:51200
    ds_read_b64_tr_b16 v[82:83], v124 offset:51712
    ds_read_b64_tr_b16 v[84:85], v124 offset:59392
    ds_read_b64_tr_b16 v[86:87], v124 offset:59904
    ds_read_b128 v[88:91], v122 offset:24576
    ds_read_b64_tr_b16 v[92:93], v124 offset:53248
    ds_read_b64_tr_b16 v[94:95], v124 offset:53760
    ds_read_b64_tr_b16 v[96:97], v124 offset:61440
    ds_read_b64_tr_b16 v[98:99], v124 offset:61952
    s_waitcnt lgkmcnt(12)
    v_mfma_f32_32x32x16_bf16 v[16:31], v[68:71], v[64:67], v[16:31]
    s_waitcnt lgkmcnt(10)
    v_mfma_f32_32x32x16_bf16 v[32:47], v[64:67], v[72:75], v[32:47]
    ds_read_b128 v[100:103], v123 offset:24576
    ds_read_b64_tr_b16 v[104:105], v124 offset:55296
    ds_read_b64_tr_b16 v[106:107], v124 offset:55808
    ds_read_b64_tr_b16 v[108:109], v124 offset:63488
    ds_read_b64_tr_b16 v[110:111], v124 offset:64000
    s_waitcnt lgkmcnt(12)
    v_mfma_f32_32x32x16_bf16 v[16:31], v[80:83], v[76:79], v[16:31]
    s_waitcnt lgkmcnt(10)
    v_mfma_f32_32x32x16_bf16 v[32:47], v[76:79], v[84:87], v[32:47]
    s_waitcnt lgkmcnt(7)
    v_mfma_f32_32x32x16_bf16 v[16:31], v[92:95], v[88:91], v[16:31]
    s_waitcnt lgkmcnt(5)
    v_mfma_f32_32x32x16_bf16 v[32:47], v[88:91], v[96:99], v[32:47]
    s_waitcnt lgkmcnt(2)
    v_mfma_f32_32x32x16_bf16 v[16:31], v[104:107], v[100:103], v[16:31]
    s_waitcnt lgkmcnt(0)
    v_mfma_f32_32x32x16_bf16 v[32:47], v[100:103], v[108:111], v[32:47]
    s_barrier
    ds_read_b128 v[64:67], v120 offset:32768
    ds_read_b64_tr_b16 v[68:69], v124 offset:0
    ds_read_b64_tr_b16 v[70:71], v124 offset:512
    ds_read_b64_tr_b16 v[72:73], v124 offset:8192
    ds_read_b64_tr_b16 v[74:75], v124 offset:8704
    ds_read_b128 v[76:79], v121 offset:32768
    ds_read_b64_tr_b16 v[80:81], v124 offset:2048
    ds_read_b64_tr_b16 v[82:83], v124 offset:2560
    ds_read_b64_tr_b16 v[84:85], v124 offset:10240
    ds_read_b64_tr_b16 v[86:87], v124 offset:10752
    ds_read_b128 v[88:91], v122 offset:32768
    ds_read_b64_tr_b16 v[92:93], v124 offset:4096
    ds_read_b64_tr_b16 v[94:95], v124 offset:4608
    ds_read_b64_tr_b16 v[96:97], v124 offset:12288
    ds_read_b64_tr_b16 v[98:99], v124 offset:12800
    s_waitcnt lgkmcnt(12)
    v_mfma_f32_32x32x16_bf16 v[16:31], v[68:71], v[64:67], v[16:31]
    s_waitcnt lgkmcnt(10)
    v_mfma_f32_32x32x16_bf16 v[32:47], v[64:67], v[72:75], v[32:47]
    ds_read_b128 v[100:103], v123 offset:32768
    ds_read_b64_tr_b16 v[104:105], v124 offset:6144
    ds_read_b64_tr_b16 v[106:107], v124 offset:6656
    ds_read_b64_tr_b16 v[108:109], v124 offset:14336
    ds_read_b64_tr_b16 v[110:111], v124 offset:14848
    s_waitcnt lgkmcnt(12)
    v_mfma_f32_32x32x16_bf16 v[16:31], v[80:83], v[76:79], v[16:31]
    s_waitcnt lgkmcnt(10)
    v_mfma_f32_32x32x16_bf16 v[32:47], v[76:79], v[84:87], v[32:47]
    s_waitcnt lgkmcnt(7)
    v_mfma_f32_32x32x16_bf16 v[16:31], v[92:95], v[88:91], v[16:31]
    s_waitcnt lgkmcnt(5)
    v_mfma_f32_32x32x16_bf16 v[32:47], v[88:91], v[96:99], v[32:47]
    s_waitcnt lgkmcnt(2)
    v_mfma_f32_32x32x16_bf16 v[16:31], v[104:107], v[100:103], v[16:31]
    s_waitcnt lgkmcnt(0)
    v_mfma_f32_32x32x16_bf16 v[32:47], v[100:103], v[108:111], v[32:47]
    s_barrier
    ds_read_b128 v[64:67], v120 offset:40960
    ds_read_b64_tr_b16 v[68:69], v124 offset:16384
    ds_read_b64_tr_b16 v[70:71], v124 offset:16896
    ds_read_b64_tr_b16 v[72:73], v124 offset:24576
    ds_read_b64_tr_b16 v[74:75], v124 offset:25088
    ds_read_b128 v[76:79], v121 offset:40960
    ds_read_b64_tr_b16 v[80:81], v124 offset:18432
    ds_read_b64_tr_b16 v[82:83], v124 offset:18944
    ds_read_b64_tr_b16 v[84:85], v124 offset:26624
    ds_read_b64_tr_b16 v[86:87], v124 offset:27136
    ds_read_b128 v[88:91], v122 offset:40960
    ds_read_b64_tr_b16 v[92:93], v124 offset:20480
    ds_read_b64_tr_b16 v[94:95], v124 offset:20992
    ds_read_b64_tr_b16 v[96:97], v124 offset:28672
    ds_read_b64_tr_b16 v[98:99], v124 offset:29184
    s_waitcnt lgkmcnt(12)
    v_mfma_f32_32x32x16_bf16 v[16:31], v[68:71], v[64:67], v[16:31]
    s_waitcnt lgkmcnt(10)
    v_mfma_f32_32x32x16_bf16 v[32:47], v[64:67], v[72:75], v[32:47]
    ds_read_b128 v[100:103], v123 offset:40960
    ds_read_b64_tr_b16 v[104:105], v124 offset:22528
    ds_read_b64_tr_b16 v[106:107], v124 offset:23040
    ds_read_b64_tr_b16 v[108:109], v124 offset:30720
    ds_read_b64_tr_b16 v[110:111], v124 offset:31232
    s_waitcnt lgkmcnt(12)
    v_mfma_f32_32x32x16_bf16 v[16:31], v[80:83], v[76:79], v[16:31]
    s_waitcnt lgkmcnt(10)
    v_mfma_f32_32x32x16_bf16 v[32:47], v[76:79], v[84:87], v[32:47]
    s_waitcnt lgkmcnt(7)
    v_mfma_f32_32x32x16_bf16 v[16:31], v[92:95], v[88:91], v[16:31]
    s_waitcnt lgkmcnt(5)
    v_mfma_f32_32x32x16_bf16 v[32:47], v[88:91], v[96:99], v[32:47]
    s_waitcnt lgkmcnt(2)
    v_mfma_f32_32x32x16_bf16 v[16:31], v[104:107], v[100:103], v[16:31]
    s_waitcnt lgkmcnt(0)
    v_mfma_f32_32x32x16_bf16 v[32:47], v[100:103], v[108:111], v[32:47]
    s_barrier
    ds_read_b128 v[64:67], v120 offset:49152
    ds_read_b64_tr_b16 v[68:69], v124 offset:32768
    ds_read_b64_tr_b16 v[70:71], v124 offset:33280
    ds_read_b64_tr_b16 v[72:73], v124 offset:40960
    ds_read_b64_tr_b16 v[74:75], v124 offset:41472
    ds_read_b128 v[76:79], v121 offset:49152
    ds_read_b64_tr_b16 v[80:81], v124 offset:34816
    ds_read_b64_tr_b16 v[82:83], v124 offset:35328
    ds_read_b64_tr_b16 v[84:85], v124 offset:43008
    ds_read_b64_tr_b16 v[86:87], v124 offset:43520
    ds_read_b128 v[88:91], v122 offset:49152
    ds_read_b64_tr_b16 v[92:93], v124 offset:36864
    ds_read_b64_tr_b16 v[94:95], v124 offset:37376
    ds_read_b64_tr_b16 v[96:97], v124 offset:45056
    ds_read_b64_tr_b16 v[98:99], v124 offset:45568
    s_waitcnt lgkmcnt(12)
    v_mfma_f32_32x32x16_bf16 v[16:31], v[68:71], v[64:67], v[16:31]
    s_waitcnt lgkmcnt(10)
    v_mfma_f32_32x32x16_bf16 v[32:47], v[64:67], v[72:75], v[32:47]
    ds_read_b128 v[100:103], v123 offset:49152
    ds_read_b64_tr_b16 v[104:105], v124 offset:38912
    ds_read_b64_tr_b16 v[106:107], v124 offset:39424
    ds_read_b64_tr_b16 v[108:109], v124 offset:47104
    ds_read_b64_tr_b16 v[110:111], v124 offset:47616
    s_waitcnt lgkmcnt(12)
    v_mfma_f32_32x32x16_bf16 v[16:31], v[80:83], v[76:79], v[16:31]
    s_waitcnt lgkmcnt(10)
    v_mfma_f32_32x32x16_bf16 v[32:47], v[76:79], v[84:87], v[32:47]
    s_waitcnt lgkmcnt(7)
    v_mfma_f32_32x32x16_bf16 v[16:31], v[92:95], v[88:91], v[16:31]
    s_waitcnt lgkmcnt(5)
    v_mfma_f32_32x32x16_bf16 v[32:47], v[88:91], v[96:99], v[32:47]
    s_waitcnt lgkmcnt(2)
    v_mfma_f32_32x32x16_bf16 v[16:31], v[104:107], v[100:103], v[16:31]
    s_waitcnt lgkmcnt(0)
    v_mfma_f32_32x32x16_bf16 v[32:47], v[100:103], v[108:111], v[32:47]
    s_barrier
    ds_read_b128 v[64:67], v120 offset:57344
    ds_read_b64_tr_b16 v[68:69], v124 offset:49152
    ds_read_b64_tr_b16 v[70:71], v124 offset:49664
    ds_read_b128 v[76:79], v121 offset:57344
    ds_read_b64_tr_b16 v[80:81], v124 offset:51200
    ds_read_b64_tr_b16 v[82:83], v124 offset:51712
    ds_read_b128 v[88:91], v122 offset:57344
    ds_read_b64_tr_b16 v[92:93], v124 offset:53248
    ds_read_b64_tr_b16 v[94:95], v124 offset:53760
    ds_read_b128 v[100:103], v123 offset:57344
    ds_read_b64_tr_b16 v[104:105], v124 offset:55296
    ds_read_b64_tr_b16 v[106:107], v124 offset:55808
    s_waitcnt lgkmcnt(9)
    v_mfma_f32_32x32x16_bf16 v[16:31], v[68:71], v[64:67], v[16:31]
    ds_read_b64_tr_b16 v[72:73], v124 offset:57344
    ds_read_b64_tr_b16 v[74:75], v124 offset:57856
    s_waitcnt lgkmcnt(8)
    v_mfma_f32_32x32x16_bf16 v[16:31], v[80:83], v[76:79], v[16:31]
    ds_read_b64_tr_b16 v[84:85], v124 offset:59392
    ds_read_b64_tr_b16 v[86:87], v124 offset:59904
    s_waitcnt lgkmcnt(7)
    v_mfma_f32_32x32x16_bf16 v[16:31], v[92:95], v[88:91], v[16:31]
    ds_read_b64_tr_b16 v[96:97], v124 offset:61440
    ds_read_b64_tr_b16 v[98:99], v124 offset:61952
    s_waitcnt lgkmcnt(6)
    v_mfma_f32_32x32x16_bf16 v[16:31], v[104:107], v[100:103], v[16:31]
    ds_read_b64_tr_b16 v[108:109], v124 offset:63488
    ds_read_b64_tr_b16 v[110:111], v124 offset:64000
    s_waitcnt lgkmcnt(6)
    v_mfma_f32_32x32x16_bf16 v[32:47], v[64:67], v[72:75], v[32:47]
    s_waitcnt lgkmcnt(4)
    v_mfma_f32_32x32x16_bf16 v[32:47], v[76:79], v[84:87], v[32:47]
    s_nop 5
    v_cvt_pk_bf16_f32 v16, v16, v17
    v_cvt_pk_bf16_f32 v17, v18, v19
    v_cvt_pk_bf16_f32 v18, v20, v21
    v_cvt_pk_bf16_f32 v19, v22, v23
    buffer_store_dwordx4 v[16:19], v125, s[40:43], 0 offen offset:0 sc1
    s_waitcnt lgkmcnt(2)
    v_mfma_f32_32x32x16_bf16 v[32:47], v[88:91], v[96:99], v[32:47]
    v_cvt_pk_bf16_f32 v20, v24, v25
    v_cvt_pk_bf16_f32 v21, v26, v27
    v_cvt_pk_bf16_f32 v22, v28, v29
    v_cvt_pk_bf16_f32 v23, v30, v31
    buffer_store_dwordx4 v[20:23], v125, s[40:43], 0 offen offset:1024 sc1
    s_waitcnt lgkmcnt(0)
    v_mfma_f32_32x32x16_bf16 v[32:47], v[100:103], v[108:111], v[32:47]
    s_nop 11
    v_cvt_pk_bf16_f32 v32, v32, v33
    v_cvt_pk_bf16_f32 v33, v34, v35
    v_cvt_pk_bf16_f32 v34, v36, v37
    v_cvt_pk_bf16_f32 v35, v38, v39
    v_cvt_pk_bf16_f32 v36, v40, v41
    v_cvt_pk_bf16_f32 v37, v42, v43
    v_cvt_pk_bf16_f32 v38, v44, v45
    v_cvt_pk_bf16_f32 v39, v46, v47
    s_waitcnt lgkmcnt(0)
    s_barrier
    ds_read_b128 v[64:67], v120 offset:0
    ds_read_b64_tr_b16 v[68:69], v124 offset:0
    ds_read_b64_tr_b16 v[70:71], v124 offset:512
    ds_read_b128 v[72:75], v121 offset:0
    ds_read_b64_tr_b16 v[76:77], v124 offset:2048
    ds_read_b64_tr_b16 v[78:79], v124 offset:2560
    ds_read_b128 v[80:83], v122 offset:0
    ds_read_b64_tr_b16 v[84:85], v124 offset:4096
    ds_read_b64_tr_b16 v[86:87], v124 offset:4608
    ds_read_b128 v[88:91], v123 offset:0
    ds_read_b64_tr_b16 v[92:93], v124 offset:6144
    ds_read_b64_tr_b16 v[94:95], v124 offset:6656
    s_waitcnt lgkmcnt(9)
    v_mfma_f32_32x32x16_bf16 v[48:63], v[68:71], v[64:67], 0
    ds_read_b128 v[96:99], v120 offset:8192
    ds_read_b64_tr_b16 v[100:101], v124 offset:8192
    ds_read_b64_tr_b16 v[102:103], v124 offset:8704
    s_waitcnt lgkmcnt(9)
    v_mfma_f32_32x32x16_bf16 v[48:63], v[76:79], v[72:75], v[48:63]
    ds_read_b128 v[104:107], v121 offset:8192
    ds_read_b64_tr_b16 v[108:109], v124 offset:10240
    ds_read_b64_tr_b16 v[110:111], v124 offset:10752
    s_waitcnt lgkmcnt(9)
    v_mfma_f32_32x32x16_bf16 v[48:63], v[84:87], v[80:83], v[48:63]
    ds_read_b128 v[112:115], v122 offset:8192
    ds_read_b64_tr_b16 v[116:117], v124 offset:12288
    ds_read_b64_tr_b16 v[118:119], v124 offset:12800
    s_waitcnt lgkmcnt(9)
    v_mfma_f32_32x32x16_bf16 v[48:63], v[92:95], v[88:91], v[48:63]
    ds_read_b128 v[64:67], v123 offset:8192
    ds_read_b64_tr_b16 v[68:69], v124 offset:14336
    ds_read_b64_tr_b16 v[70:71], v124 offset:14848
    s_waitcnt lgkmcnt(9)
    v_mfma_f32_32x32x16_bf16 v[48:63], v[100:103], v[96:99], v[48:63]
    s_waitcnt lgkmcnt(6)
    s_waitcnt lgkmcnt(3)
    s_waitcnt lgkmcnt(0)
    ds_write_b128 v127, v[16:19]
    ds_write_b128 v127, v[20:23] offset:1024
    ds_write_b128 v128, v[32:35]
    ds_write_b128 v128, v[36:39] offset:512
    v_mov_b32 v252, s54
    v_mov_b32 v253, 0
    s_waitcnt vmcnt(0)
    s_mov_b64 exec, 1
    buffer_store_dword v252, v253, s[36:39], s15 offen sc1
    s_mov_b64 exec, -1
    buffer_store_dwordx4 v[32:35], v126, s[44:47], 0 offen sc1
    buffer_store_dwordx4 v[36:39], v126, s[44:47], 0 offen offset:512 sc1
    s_barrier
    ds_read_b128 v[72:75], v120 offset:16384
    ds_read_b64_tr_b16 v[76:77], v124 offset:16384
    ds_read_b64_tr_b16 v[78:79], v124 offset:16896
    v_mfma_f32_32x32x16_bf16 v[48:63], v[108:111], v[104:107], v[48:63]
    ds_read_b128 v[80:83], v121 offset:16384
    ds_read_b64_tr_b16 v[84:85], v124 offset:18432
    ds_read_b64_tr_b16 v[86:87], v124 offset:18944
    v_mfma_f32_32x32x16_bf16 v[48:63], v[116:119], v[112:115], v[48:63]
    ds_read_b128 v[88:91], v122 offset:16384
    ds_read_b64_tr_b16 v[92:93], v124 offset:20480
    ds_read_b64_tr_b16 v[94:95], v124 offset:20992
    v_mfma_f32_32x32x16_bf16 v[48:63], v[68:71], v[64:67], v[48:63]
    ds_read_b128 v[96:99], v123 offset:16384
    ds_read_b64_tr_b16 v[100:101], v124 offset:22528
    ds_read_b64_tr_b16 v[102:103], v124 offset:23040
    s_waitcnt lgkmcnt(9)
    v_mfma_f32_32x32x16_bf16 v[48:63], v[76:79], v[72:75], v[48:63]
    ds_read_b128 v[104:107], v120 offset:24576
    ds_read_b64_tr_b16 v[108:109], v124 offset:24576
    ds_read_b64_tr_b16 v[110:111], v124 offset:25088
    s_waitcnt lgkmcnt(9)
    v_mfma_f32_32x32x16_bf16 v[48:63], v[84:87], v[80:83], v[48:63]
    ds_read_b128 v[112:115], v121 offset:24576
    ds_read_b64_tr_b16 v[116:117], v124 offset:26624
    ds_read_b64_tr_b16 v[118:119], v124 offset:27136
    s_waitcnt lgkmcnt(9)
    v_mfma_f32_32x32x16_bf16 v[48:63], v[92:95], v[88:91], v[48:63]
    ds_read_b128 v[64:67], v122 offset:24576
    ds_read_b64_tr_b16 v[68:69], v124 offset:28672
    ds_read_b64_tr_b16 v[70:71], v124 offset:29184
    s_waitcnt lgkmcnt(9)
    v_mfma_f32_32x32x16_bf16 v[48:63], v[100:103], v[96:99], v[48:63]
    ds_read_b128 v[72:75], v123 offset:24576
    ds_read_b64_tr_b16 v[76:77], v124 offset:30720
    ds_read_b64_tr_b16 v[78:79], v124 offset:31232
    s_waitcnt lgkmcnt(9)
    v_mfma_f32_32x32x16_bf16 v[48:63], v[108:111], v[104:107], v[48:63]
    s_waitcnt lgkmcnt(6)
    s_waitcnt lgkmcnt(3)
    s_waitcnt lgkmcnt(0)
    s_barrier
    ds_read_b128 v[80:83], v120 offset:32768
    ds_read_b64_tr_b16 v[84:85], v124 offset:32768
    ds_read_b64_tr_b16 v[86:87], v124 offset:33280
    v_mfma_f32_32x32x16_bf16 v[48:63], v[116:119], v[112:115], v[48:63]
    ds_read_b128 v[88:91], v121 offset:32768
    ds_read_b64_tr_b16 v[92:93], v124 offset:34816
    ds_read_b64_tr_b16 v[94:95], v124 offset:35328
    v_mfma_f32_32x32x16_bf16 v[48:63], v[68:71], v[64:67], v[48:63]
    ds_read_b128 v[96:99], v122 offset:32768
    ds_read_b64_tr_b16 v[100:101], v124 offset:36864
    ds_read_b64_tr_b16 v[102:103], v124 offset:37376
    v_mfma_f32_32x32x16_bf16 v[48:63], v[76:79], v[72:75], v[48:63]
    ds_read_b128 v[104:107], v123 offset:32768
    ds_read_b64_tr_b16 v[108:109], v124 offset:38912
    ds_read_b64_tr_b16 v[110:111], v124 offset:39424
    s_waitcnt lgkmcnt(9)
    v_mfma_f32_32x32x16_bf16 v[48:63], v[84:87], v[80:83], v[48:63]
    ds_read_b128 v[112:115], v120 offset:40960
    ds_read_b64_tr_b16 v[116:117], v124 offset:40960
    ds_read_b64_tr_b16 v[118:119], v124 offset:41472
    s_waitcnt lgkmcnt(9)
    v_mfma_f32_32x32x16_bf16 v[48:63], v[92:95], v[88:91], v[48:63]
    ds_read_b128 v[64:67], v121 offset:40960
    ds_read_b64_tr_b16 v[68:69], v124 offset:43008
    ds_read_b64_tr_b16 v[70:71], v124 offset:43520
    s_waitcnt lgkmcnt(9)
    v_mfma_f32_32x32x16_bf16 v[48:63], v[100:103], v[96:99], v[48:63]
    ds_read_b128 v[72:75], v122 offset:40960
    ds_read_b64_tr_b16 v[76:77], v124 offset:45056
    ds_read_b64_tr_b16 v[78:79], v124 offset:45568
    s_waitcnt lgkmcnt(9)
    v_mfma_f32_32x32x16_bf16 v[48:63], v[108:111], v[104:107], v[48:63]
    ds_read_b128 v[80:83], v123 offset:40960
    ds_read_b64_tr_b16 v[84:85], v124 offset:47104
    ds_read_b64_tr_b16 v[86:87], v124 offset:47616
    s_waitcnt lgkmcnt(9)
    v_mfma_f32_32x32x16_bf16 v[48:63], v[116:119], v[112:115], v[48:63]
    s_waitcnt lgkmcnt(6)
    s_waitcnt lgkmcnt(3)
    s_waitcnt lgkmcnt(0)
    s_add_u32 s15, s15, 65536
    v_mov_b32 v19, s54
    v_mov_b32 v20, 0
    s_waitcnt vmcnt(0)
    s_mov_b64 exec, 1
    buffer_store_dword v19, v20, s[36:39], s15 offen sc1
    s_mov_b64 exec, -1
    s_barrier
    v_lshlrev_b32 v252, 6, v1
    s_lshl_b32 s60, s51, 5
    s_add_u32 s60, s60, s50
    s_lshl_b32 s60, s60, 8
    s_add_u32 s60, s60, 64512
    s_min_u32 s58, s50, 4
    s_sub_u32 s58, 4, s58
    s_lshl_b32 s58, s58, 2
    s_lshl_b32 s58, 0xffff, s58
    s_and_b32 s58, s58, 0xffff
    s_cbranch_scc0 L_np0
    s_cmp_lg_u32 s52, 0
    s_cbranch_scc1 L_np0
    s_mov_b32 exec_lo, s58
    s_mov_b32 exec_hi, 0
    buffer_load_dword v16, v252, s[36:39], s60 offen sc1
    s_mov_b64 exec, -1
L_np0:
    ds_read_b128 v[88:91], v120 offset:49152
    ds_read_b64_tr_b16 v[92:93], v124 offset:49152
    ds_read_b64_tr_b16 v[94:95], v124 offset:49664
    v_mfma_f32_32x32x16_bf16 v[48:63], v[68:71], v[64:67], v[48:63]
    ds_read_b128 v[96:99], v121 offset:49152
    ds_read_b64_tr_b16 v[100:101], v124 offset:51200
    ds_read_b64_tr_b16 v[102:103], v124 offset:51712
    v_mfma_f32_32x32x16_bf16 v[48:63], v[76:79], v[72:75], v[48:63]
    ds_read_b128 v[104:107], v122 offset:49152
    ds_read_b64_tr_b16 v[108:109], v124 offset:53248
    ds_read_b64_tr_b16 v[110:111], v124 offset:53760
    v_mfma_f32_32x32x16_bf16 v[48:63], v[84:87], v[80:83], v[48:63]
    ds_read_b128 v[112:115], v123 offset:49152
    ds_read_b64_tr_b16 v[116:117], v124 offset:55296
    ds_read_b64_tr_b16 v[118:119], v124 offset:55808
    s_waitcnt lgkmcnt(9)
    v_mfma_f32_32x32x16_bf16 v[48:63], v[92:95], v[88:91], v[48:63]
    ds_read_b128 v[64:67], v120 offset:57344
    ds_read_b64_tr_b16 v[68:69], v124 offset:57344
    ds_read_b64_tr_b16 v[70:71], v124 offset:57856
    s_waitcnt lgkmcnt(9)
    v_mfma_f32_32x32x16_bf16 v[48:63], v[100:103], v[96:99], v[48:63]
    ds_read_b128 v[72:75], v121 offset:57344
    ds_read_b64_tr_b16 v[76:77], v124 offset:59392
    ds_read_b64_tr_b16 v[78:79], v124 offset:59904
    s_waitcnt lgkmcnt(9)
    v_mfma_f32_32x32x16_bf16 v[48:63], v[108:111], v[104:107], v[48:63]
    ds_read_b128 v[80:83], v122 offset:57344
    ds_read_b64_tr_b16 v[84:85], v124 offset:61440
    ds_read_b64_tr_b16 v[86:87], v124 offset:61952
    s_waitcnt lgkmcnt(9)
    v_mfma_f32_32x32x16_bf16 v[48:63], v[116:119], v[112:115], v[48:63]
    ds_read_b128 v[88:91], v123 offset:57344
    ds_read_b64_tr_b16 v[92:93], v124 offset:63488
    ds_read_b64_tr_b16 v[94:95], v124 offset:64000
    s_waitcnt lgkmcnt(9)
    v_mfma_f32_32x32x16_bf16 v[48:63], v[68:71], v[64:67], v[48:63]
    s_waitcnt lgkmcnt(6)
    v_mfma_f32_32x32x16_bf16 v[48:63], v[76:79], v[72:75], v[48:63]
    s_waitcnt lgkmcnt(3)
    v_mfma_f32_32x32x16_bf16 v[48:63], v[84:87], v[80:83], v[48:63]
    s_waitcnt lgkmcnt(0)
    v_mfma_f32_32x32x16_bf16 v[48:63], v[92:95], v[88:91], v[48:63]
    s_lshl_b32 s55, s4, 1
    s_add_u32 s55, s55, s5
    s_lshl_b32 s55, s55, 13
    s_add_u32 s55, s55, 69632
    v_lshlrev_b32 v127, 4, v1
    v_add_u32 v127, s55, v127
    s_nop 6
    v_mul_f32 v48, s59, v48
    v_mul_f32 v49, s59, v49
    v_mul_f32 v50, s59, v50
    v_mul_f32 v51, s59, v51
    v_mul_f32 v52, s59, v52
    v_mul_f32 v53, s59, v53
    v_mul_f32 v54, s59, v54
    v_mul_f32 v55, s59, v55
    v_mul_f32 v56, s59, v56
    v_mul_f32 v57, s59, v57
    v_mul_f32 v58, s59, v58
    v_mul_f32 v59, s59, v59
    v_mul_f32 v60, s59, v60
    v_mul_f32 v61, s59, v61
    v_mul_f32 v62, s59, v62
    v_mul_f32 v63, s59, v63
    v_cvt_pk_bf16_f32 v48, v48, v49
    v_cvt_pk_bf16_f32 v49, v50, v51
    v_cvt_pk_bf16_f32 v50, v52, v53
    v_cvt_pk_bf16_f32 v51, v54, v55
    v_cvt_pk_bf16_f32 v52, v56, v57
    v_cvt_pk_bf16_f32 v53, v58, v59
    v_cvt_pk_bf16_f32 v54, v60, v61
    v_cvt_pk_bf16_f32 v55, v62, v63
    ds_write_b128 v127, v[48:51]
    ds_write_b128 v127, v[52:55] offset:1024
    s_cmp_lg_u32 s52, 0
    s_cbranch_scc1 L_p1done
    s_cmp_eq_u32 s58, 0
    s_cbranch_scc1 L_p1done
    s_mov_b32 exec_lo, s58
    s_mov_b32 exec_hi, 0
    s_mov_b32 s57, 0
L_p1:
    s_waitcnt vmcnt(0)
    v_cmp_ne_u32 vcc, s54, v16
    s_add_u32 s57, s57, 1
    s_cbranch_vccz L_p1ok
    buffer_load_dword v16, v252, s[36:39], s60 offen sc1
    s_cmp_lt_u32 s57, 20000
    s_cbranch_scc1 L_p1
L_p1ok:
    s_mov_b64 exec, -1
L_p1done:
    s_waitcnt lgkmcnt(0)
    s_barrier
L_attn:
    s_cmp_lt_u32 s52, 4
    s_cbranch_scc1 L_nvfl
    s_mov_b64 exec, 15
    buffer_load_dword v2, v3, s[36:39], s98 offen sc1
    s_mov_b64 exec, -1
L_nvfl:
    ds_read_b128 v[248:251], v9
    ds_read_b128 v[68:71], v10
    s_cmp_lt_u32 s52, 4
    s_cbranch_scc1 L_k7g
    v_subrev_u32 v252, 4096, v10
    ds_read_b128 v[160:163], v252
    s_branch L_k7d
L_k7g:
    s_add_u32 s55, s62, 28672
    s_cmp_ge_i32 s55, 0
    s_cselect_b32 s42, 0x40000, 0
    s_max_i32 s55, s55, 0
    buffer_load_dwordx4 v[160:163], v5, s[40:43], s55 offen sc1
L_k7d:
    s_add_u32 s55, s62, 24576
    s_cmp_ge_i32 s55, 0
    s_cselect_b32 s42, 0x40000, 0
    s_max_i32 s55, s55, 0
    buffer_load_dwordx4 v[144:147], v5, s[40:43], s55 offen sc1
    s_add_u32 s55, s62, 20480
    s_cmp_ge_i32 s55, 0
    s_cselect_b32 s42, 0x40000, 0
    s_max_i32 s55, s55, 0
    buffer_load_dwordx4 v[128:131], v5, s[40:43], s55 offen sc1
    s_add_u32 s55, s62, 16384
    s_cmp_ge_i32 s55, 0
    s_cselect_b32 s42, 0x40000, 0
    s_max_i32 s55, s55, 0
    buffer_load_dwordx4 v[112:115], v5, s[40:43], s55 offen sc1
    ds_write2_b32 v14, v13, v13 offset0:0 offset1:16
    ds_write2_b32 v14, v13, v13 offset0:32 offset1:48
    ds_write_b32 v14, v13 offset:256
    s_waitcnt lgkmcnt(3)
    v_mfma_f32_32x32x16_bf16 v[192:207], v[68:71], v[248:251], 0
    s_nop 9
    s_cmp_eq_u32 s63, 0
    s_cbranch_scc1 L_first
L_firstback:
    v_max3_f32 v9, v192, v193, v194
    v_max3_f32 v10, v195, v196, v197
    v_max3_f32 v9, v9, v198, v199
    v_max3_f32 v10, v10, v200, v201
    v_max3_f32 v9, v9, v202, v203
    v_max3_f32 v10, v10, v204, v205
    v_max3_f32 v9, v9, v206, v207
    v_max_f32 v9, v9, v10
    s_nop 0
    v_mov_b32 v10, v9
    s_nop 1
    v_permlane32_swap_b32 v9, v10
    s_nop 1
    v_max_f32 v9, v9, v10
    v_sub_f32 v208, 0, v9
    v_mov_b32 v209, v208
    v_mov_b32 v210, v208
    v_mov_b32 v211, v208
    v_mov_b32 v212, v208
    v_mov_b32 v213, v208
    v_mov_b32 v214, v208
    v_mov_b32 v215, v208
    v_mov_b32 v216, v208
    v_mov_b32 v217, v208
    v_mov_b32 v218, v208
    v_mov_b32 v219, v208
    v_mov_b32 v220, v208
    v_mov_b32 v221, v208
    v_mov_b32 v222, v208
    v_mov_b32 v223, v208
    s_waitcnt lgkmcnt(0)
    s_nop 0
    v_mfma_f32_32x32x16_bf16 v[192:207], v[68:71], v[248:251], v[208:223]
    s_add_u32 s55, s62, 12288
    s_cmp_ge_i32 s55, 0
    s_cselect_b32 s42, 0x40000, 0
    s_max_i32 s55, s55, 0
    buffer_load_dwordx4 v[96:99], v5, s[40:43], s55 offen sc1
    s_add_u32 s55, s62, 8192
    s_cmp_ge_i32 s55, 0
    s_cselect_b32 s42, 0x40000, 0
    s_max_i32 s55, s55, 0
    buffer_load_dwordx4 v[80:83], v5, s[40:43], s55 offen sc1
    s_add_u32 s55, s62, 4096
    s_cmp_ge_i32 s55, 0
    s_cselect_b32 s42, 0x40000, 0
    s_max_i32 s55, s55, 0
    buffer_load_dwordx4 v[64:67], v5, s[40:43], s55 offen sc1
    s_add_u32 s55, s62, 0
    s_cmp_ge_i32 s55, 0
    s_cselect_b32 s42, 0x40000, 0
    s_max_i32 s55, s55, 0
    buffer_load_dwordx4 v[60:63], v5, s[40:43], s55 offen sc1
    s_cmp_lt_u32 s52, 4
    s_cbranch_scc1 L_nz2
    ds_read_b64_tr_b16 v[176:177], v132 offset:0
    ds_read_b64_tr_b16 v[178:179], v132 offset:2048
    ds_read_b64_tr_b16 v[180:181], v133 offset:0
    ds_read_b64_tr_b16 v[182:183], v133 offset:2048
    ds_read_b64_tr_b16 v[184:185], v134 offset:0
    ds_read_b64_tr_b16 v[186:187], v134 offset:2048
    ds_read_b64_tr_b16 v[188:189], v135 offset:0
    ds_read_b64_tr_b16 v[190:191], v135 offset:2048
    s_waitcnt lgkmcnt(6)
    v_mfma_f32_16x16x32_bf16 v[72:75], v[176:179], v[16:19], 0
    v_mfma_f32_16x16x32_bf16 v[76:79], v[176:179], v[20:23], 0
    s_waitcnt lgkmcnt(4)
    v_mfma_f32_16x16x32_bf16 v[84:87], v[180:183], v[16:19], 0
    v_mfma_f32_16x16x32_bf16 v[88:91], v[180:183], v[20:23], 0
    s_waitcnt lgkmcnt(2)
    v_mfma_f32_16x16x32_bf16 v[100:103], v[184:187], v[16:19], 0
    v_mfma_f32_16x16x32_bf16 v[104:107], v[184:187], v[20:23], 0
    s_waitcnt lgkmcnt(0)
    v_mfma_f32_16x16x32_bf16 v[116:119], v[188:191], v[16:19], 0
    v_mfma_f32_16x16x32_bf16 v[120:123], v[188:191], v[20:23], 0
    v_xor_b32 v16, s6, v16
    v_xor_b32 v17, s6, v17
    v_xor_b32 v18, s6, v18
    v_xor_b32 v19, s6, v19
    v_xor_b32 v20, s6, v20
    v_xor_b32 v21, s6, v21
    v_xor_b32 v22, s6, v22
    v_xor_b32 v23, s6, v23
    v_cvt_pk_bf16_f32 v72, v72, v73
    v_cvt_pk_bf16_f32 v73, v74, v75
    v_cvt_pk_bf16_f32 v74, v76, v77
    v_cvt_pk_bf16_f32 v75, v78, v79
    v_cvt_pk_bf16_f32 v84, v84, v85
    v_cvt_pk_bf16_f32 v85, v86, v87
    v_cvt_pk_bf16_f32 v86, v88, v89
    v_cvt_pk_bf16_f32 v87, v90, v91
    v_cvt_pk_bf16_f32 v100, v100, v101
    v_cvt_pk_bf16_f32 v101, v102, v103
    v_cvt_pk_bf16_f32 v102, v104, v105
    v_cvt_pk_bf16_f32 v103, v106, v107
    v_cvt_pk_bf16_f32 v116, v116, v117
    v_cvt_pk_bf16_f32 v117, v118, v119
    v_cvt_pk_bf16_f32 v118, v120, v121
    v_cvt_pk_bf16_f32 v119, v122, v123
L_nz2:
    s_cmp_lt_u32 s52, 4
    s_cbranch_scc0 L_rw7
    s_waitcnt vmcnt(7)
L_rw7:
    s_cmp_eq_u32 s63, 0
    s_cbranch_scc1 L_miss7
L_back7:
    v_mfma_f32_32x32x16_bf16 v[176:191], v[160:163], v[248:251], v[208:223]
    s_waitcnt vmcnt(6)
    s_cmp_lt_u32 s52, 4
    s_cbranch_scc0 L_rw6
    s_waitcnt vmcnt(6)
L_rw6:
    s_cmp_eq_u32 s63, 1
    s_cbranch_scc1 L_miss6
L_back6:
    v_mfma_f32_32x32x16_bf16 v[160:175], v[144:147], v[248:251], v[208:223]
    s_nop 7
    v_exp_f32 v176, v176
    v_exp_f32 v177, v177
    s_cmp_lt_u32 s52, 4
    s_cbranch_scc1 L_nov
    s_add_u32 s55, s50, s7
    s_cmp_lt_u32 s55, 4
    s_cbranch_scc1 L_vok
    s_waitcnt vmcnt(7)
    s_mov_b64 exec, 15
    v_cmp_ne_u32 vcc, s54, v2
    s_nop 0
    s_cbranch_vccz L_vok
    s_mov_b32 s55, 0
    buffer_load_dword v2, v3, s[36:39], s98 offen sc1
L_pv:
    s_waitcnt vmcnt(0)
    v_cmp_ne_u32 vcc, s54, v2
    s_add_u32 s55, s55, 1
    s_cbranch_vccz L_pvok
    buffer_load_dword v2, v3, s[36:39], s98 offen sc1
    s_cmp_lt_u32 s55, 20000
    s_cbranch_scc1 L_pv
L_pvok:
    s_mov_b64 exec, -1
L_vok:
    s_mov_b64 exec, -1
    s_add_u32 m0, s3, 0
    s_nop 0
    buffer_load_dwordx4 v12, s[44:47], 0 offen offset:0 sc1 lds
    buffer_load_dwordx4 v12, s[44:47], 0 offen offset:1024 sc1 lds
    buffer_load_dwordx4 v12, s[44:47], 0 offen offset:2048 sc1 lds
    buffer_load_dwordx4 v12, s[44:47], 0 offen offset:3072 sc1 lds
    v_add_u32 v12, 4096, v12
    s_add_u32 m0, s3, 4096
    s_nop 0
    buffer_load_dwordx4 v12, s[44:47], 0 offen offset:0 sc1 lds
    buffer_load_dwordx4 v12, s[44:47], 0 offen offset:1024 sc1 lds
    buffer_load_dwordx4 v12, s[44:47], 0 offen offset:2048 sc1 lds
    buffer_load_dwordx4 v12, s[44:47], 0 offen offset:3072 sc1 lds
L_nov:
    v_exp_f32 v178, v178
    v_exp_f32 v179, v179
    v_cvt_pk_bf16_f32 v176, v176, v177
    v_exp_f32 v180, v180
    v_exp_f32 v181, v181
    v_cvt_pk_bf16_f32 v177, v178, v179
    v_exp_f32 v182, v182
    v_exp_f32 v183, v183
    v_cvt_pk_bf16_f32 v178, v180, v181
    v_exp_f32 v184, v184
    s_waitcnt vmcnt(13)
    s_cmp_lt_u32 s52, 4
    s_cbranch_scc0 L_rw5
    s_waitcnt vmcnt(5)
L_rw5:
    s_cmp_eq_u32 s63, 2
    s_cbranch_scc1 L_miss5
L_back5:
    v_mfma_f32_32x32x16_bf16 v[144:159], v[128:131], v[248:251], v[208:223]
    v_exp_f32 v185, v185
    v_cvt_pk_bf16_f32 v179, v182, v183
    v_exp_f32 v186, v186
    v_exp_f32 v187, v187
    v_cvt_pk_bf16_f32 v180, v184, v185
    v_exp_f32 v188, v188
    v_exp_f32 v189, v189
    v_cvt_pk_bf16_f32 v181, v186, v187
    v_exp_f32 v190, v190
    v_exp_f32 v191, v191
    v_cvt_pk_bf16_f32 v182, v188, v189
    s_nop 0
    v_cvt_pk_bf16_f32 v183, v190, v191
    v_exp_f32 v160, v160
    v_exp_f32 v161, v161
    v_exp_f32 v162, v162
    v_exp_f32 v163, v163
    s_waitcnt vmcnt(12)
    s_cmp_lt_u32 s52, 4
    s_cbranch_scc0 L_rw4
    s_waitcnt vmcnt(4)
L_rw4:
    s_cmp_eq_u32 s63, 3
    s_cbranch_scc1 L_miss4
L_back4:
    v_mfma_f32_32x32x16_bf16 v[128:143], v[112:115], v[248:251], v[208:223]
    v_cvt_pk_bf16_f32 v160, v160, v161
    v_exp_f32 v164, v164
    v_exp_f32 v165, v165
    v_cvt_pk_bf16_f32 v161, v162, v163
    v_exp_f32 v166, v166
    v_exp_f32 v167, v167
    s_cmp_lt_u32 s52, 4
    s_cbranch_scc1 L_nzs3
    s_add_u32 s55, s12, 49152
    s_mov_b32 exec_lo, s14
    s_mov_b32 exec_hi, s14
    buffer_store_dwordx4 v[116:119], v15, s[36:39], s55 offen sc1
    s_mov_b64 exec, -1
L_nzs3:
    v_cvt_pk_bf16_f32 v162, v164, v165
    v_exp_f32 v168, v168
    v_exp_f32 v169, v169
    v_cvt_pk_bf16_f32 v163, v166, v167
    v_exp_f32 v170, v170
    v_exp_f32 v171, v171
    s_waitcnt vmcnt(12)
    s_cmp_lt_u32 s52, 4
    s_cbranch_scc0 L_rw3
    s_waitcnt vmcnt(3)
L_rw3:
    s_cmp_eq_u32 s63, 4
    s_cbranch_scc1 L_miss3
L_back3:
    v_mfma_f32_32x32x16_bf16 v[112:127], v[96:99], v[248:251], v[208:223]
    v_cvt_pk_bf16_f32 v164, v168, v169
    v_exp_f32 v172, v172
    v_exp_f32 v173, v173
    v_cvt_pk_bf16_f32 v165, v170, v171
    v_exp_f32 v174, v174
    v_exp_f32 v175, v175
    v_cvt_pk_bf16_f32 v166, v172, v173
    s_nop 0
    v_cvt_pk_bf16_f32 v167, v174, v175
    s_cmp_lt_u32 s52, 4
    s_cbranch_scc1 L_nzs2
    s_add_u32 s55, s12, 32768
    s_mov_b32 exec_lo, s14
    s_mov_b32 exec_hi, s14
    buffer_store_dwordx4 v[100:103], v15, s[36:39], s55 offen sc1
    s_mov_b64 exec, -1
L_nzs2:
    v_exp_f32 v144, v144
    v_exp_f32 v145, v145
    s_waitcnt vmcnt(12)
    s_cmp_lt_u32 s52, 4
    s_cbranch_scc0 L_rw2
    s_waitcnt vmcnt(2)
L_rw2:
    s_cmp_eq_u32 s63, 5
    s_cbranch_scc1 L_miss2
L_back2:
    v_mfma_f32_32x32x16_bf16 v[96:111], v[80:83], v[248:251], v[208:223]
    v_exp_f32 v146, v146
    v_exp_f32 v147, v147
    v_cvt_pk_bf16_f32 v144, v144, v145
    v_exp_f32 v148, v148
    v_exp_f32 v149, v149
    v_cvt_pk_bf16_f32 v145, v146, v147
    s_cmp_lt_u32 s52, 4
    s_cbranch_scc1 L_nzs1
    s_add_u32 s55, s12, 16384
    s_mov_b32 exec_lo, s14
    s_mov_b32 exec_hi, s14
    buffer_store_dwordx4 v[84:87], v15, s[36:39], s55 offen sc1
    s_mov_b64 exec, -1
L_nzs1:
    v_exp_f32 v150, v150
    v_exp_f32 v151, v151
    s_waitcnt vmcnt(12)
    s_cmp_lt_u32 s52, 4
    s_cbranch_scc0 L_rw1
    s_waitcnt vmcnt(1)
L_rw1:
    s_cmp_eq_u32 s63, 6
    s_cbranch_scc1 L_miss1
L_back1:
    v_mfma_f32_32x32x16_bf16 v[80:95], v[64:67], v[248:251], v[208:223]
    v_cvt_pk_bf16_f32 v146, v148, v149
    v_exp_f32 v152, v152
    v_exp_f32 v153, v153
    v_cvt_pk_bf16_f32 v147, v150, v151
    v_exp_f32 v154, v154
    v_exp_f32 v155, v155
    s_cmp_lt_u32 s52, 4
    s_cbranch_scc1 L_nzs0
    s_add_u32 s55, s12, 0
    s_mov_b32 exec_lo, s13
    s_mov_b32 exec_hi, s13
    buffer_store_dwordx4 v[72:75], v15, s[36:39], s55 offen sc1
    s_mov_b64 exec, -1
L_nzs0:
    v_cvt_pk_bf16_f32 v148, v152, v153
    v_exp_f32 v156, v156
    s_waitcnt vmcnt(12)
    s_cmp_lt_u32 s52, 4
    s_cbranch_scc0 L_rw0
    s_waitcnt vmcnt(0)
L_rw0:
    s_cmp_eq_u32 s63, 7
    s_cbranch_scc1 L_miss0
L_back0:
    v_mfma_f32_32x32x16_bf16 v[64:79], v[60:63], v[248:251], v[208:223]
    v_exp_f32 v157, v157
    v_cvt_pk_bf16_f32 v149, v154, v155
    v_exp_f32 v158, v158
    v_exp_f32 v159, v159
    v_cvt_pk_bf16_f32 v150, v156, v157
    s_nop 0
    v_cvt_pk_bf16_f32 v151, v158, v159
    v_exp_f32 v128, v128
    v_exp_f32 v129, v129
    v_exp_f32 v130, v130
    v_exp_f32 v131, v131
    v_cvt_pk_bf16_f32 v128, v128, v129
    v_exp_f32 v132, v132
    v_exp_f32 v133, v133
    v_cvt_pk_bf16_f32 v129, v130, v131
    v_exp_f32 v134, v134
    v_exp_f32 v135, v135
    v_cvt_pk_bf16_f32 v130, v132, v133
    v_exp_f32 v136, v136
    s_add_u32 m0, s11, 0
    s_mov_b32 s55, 0
    buffer_load_dwordx4 v11, s[28:31], s55 offen  lds
    v_exp_f32 v137, v137
    v_cvt_pk_bf16_f32 v131, v134, v135
    v_exp_f32 v138, v138
    v_exp_f32 v139, v139
    v_cvt_pk_bf16_f32 v132, v136, v137
    v_exp_f32 v140, v140
    v_exp_f32 v141, v141
    v_cvt_pk_bf16_f32 v133, v138, v139
    v_exp_f32 v142, v142
    v_exp_f32 v143, v143
    v_cvt_pk_bf16_f32 v134, v140, v141
    s_nop 0
    v_cvt_pk_bf16_f32 v135, v142, v143
    v_exp_f32 v112, v112
    v_exp_f32 v113, v113
    v_exp_f32 v114, v114
    v_exp_f32 v115, v115
    v_cvt_pk_bf16_f32 v112, v112, v113
    v_exp_f32 v116, v116
    v_exp_f32 v117, v117
    v_cvt_pk_bf16_f32 v113, v114, v115
    v_exp_f32 v118, v118
    v_exp_f32 v119, v119
    v_cvt_pk_bf16_f32 v114, v116, v117
    v_exp_f32 v120, v120
    s_add_u32 m0, s11, 1024
    s_mov_b32 s55, 8192
    buffer_load_dwordx4 v11, s[28:31], s55 offen  lds
    v_exp_f32 v121, v121
    v_cvt_pk_bf16_f32 v115, v118, v119
    v_exp_f32 v122, v122
    v_exp_f32 v123, v123
    v_cvt_pk_bf16_f32 v116, v120, v121
    v_exp_f32 v124, v124
    v_exp_f32 v125, v125
    v_cvt_pk_bf16_f32 v117, v122, v123
    v_exp_f32 v126, v126
    v_exp_f32 v127, v127
    v_cvt_pk_bf16_f32 v118, v124, v125
    s_nop 0
    v_cvt_pk_bf16_f32 v119, v126, v127
    s_waitcnt vmcnt(6)
    s_barrier
    s_mov_b64 exec, s[96:97]
    ds_read_b128 v[224:227], v7 offset:0
    ds_read_b128 v[228:231], v7 offset:512
    s_mov_b64 exec, -1
    s_mov_b64 exec, s[96:97]
    ds_read_b128 v[232:235], v6 offset:24576
    ds_read_b128 v[236:239], v6 offset:25088
    s_mov_b64 exec, -1
    v_cndmask_b32 v192, v64, v192, s[64:65]
    v_cndmask_b32 v193, v65, v193, s[66:67]
    v_cndmask_b32 v194, v66, v194, s[68:69]
    v_cndmask_b32 v195, v67, v195, s[70:71]
    v_cndmask_b32 v196, v68, v196, s[72:73]
    v_cndmask_b32 v197, v69, v197, s[74:75]
    v_cndmask_b32 v198, v70, v198, s[76:77]
    v_cndmask_b32 v199, v71, v199, s[78:79]
    v_cndmask_b32 v200, v72, v200, s[80:81]
    v_cndmask_b32 v201, v73, v201, s[82:83]
    v_cndmask_b32 v202, v74, v202, s[84:85]
    v_cndmask_b32 v203, v75, v203, s[86:87]
    v_cndmask_b32 v204, v76, v204, s[88:89]
    v_cndmask_b32 v205, v77, v205, s[90:91]
    v_cndmask_b32 v206, v78, v206, s[92:93]
    v_cndmask_b32 v207, v79, v207, s[94:95]
    s_waitcnt lgkmcnt(3)
    v_mfma_f32_32x32x16_bf16 v[208:223], v[224:227], v[176:179], 0
    v_exp_f32 v192, v192
    v_exp_f32 v193, v193
    v_exp_f32 v194, v194
    v_exp_f32 v195, v195
    s_waitcnt lgkmcnt(2)
    v_mfma_f32_32x32x16_bf16 v[208:223], v[228:231], v[180:183], v[208:223]
    s_mov_b64 exec, s[96:97]
    ds_read_b128 v[224:227], v6 offset:20480
    ds_read_b128 v[228:231], v6 offset:20992
    s_mov_b64 exec, -1
    v_cvt_pk_bf16_f32 v192, v192, v193
    v_exp_f32 v196, v196
    v_exp_f32 v197, v197
    v_cvt_pk_bf16_f32 v193, v194, v195
    s_waitcnt lgkmcnt(3)
    v_mfma_f32_32x32x16_bf16 v[208:223], v[232:235], v[160:163], v[208:223]
    v_exp_f32 v198, v198
    s_add_u32 m0, s11, 2048
    s_mov_b32 s55, 16384
    buffer_load_dwordx4 v11, s[28:31], s55 offen  lds
    v_exp_f32 v199, v199
    v_cvt_pk_bf16_f32 v194, v196, v197
    v_exp_f32 v200, v200
    s_waitcnt lgkmcnt(2)
    v_mfma_f32_32x32x16_bf16 v[208:223], v[236:239], v[164:167], v[208:223]
    s_mov_b64 exec, s[96:97]
    ds_read_b128 v[232:235], v6 offset:16384
    ds_read_b128 v[236:239], v6 offset:16896
    s_mov_b64 exec, -1
    v_exp_f32 v201, v201
    v_cvt_pk_bf16_f32 v195, v198, v199
    v_exp_f32 v202, v202
    v_exp_f32 v203, v203
    s_waitcnt lgkmcnt(3)
    v_mfma_f32_32x32x16_bf16 v[208:223], v[224:227], v[144:147], v[208:223]
    v_cvt_pk_bf16_f32 v196, v200, v201
    v_exp_f32 v204, v204
    v_exp_f32 v205, v205
    v_cvt_pk_bf16_f32 v197, v202, v203
    s_waitcnt lgkmcnt(2)
    v_mfma_f32_32x32x16_bf16 v[208:223], v[228:231], v[148:151], v[208:223]
    s_mov_b64 exec, s[96:97]
    ds_read_b128 v[224:227], v6 offset:12288
    ds_read_b128 v[228:231], v6 offset:12800
    s_mov_b64 exec, -1
    v_exp_f32 v206, v206
    s_add_u32 m0, s11, 3072
    s_mov_b32 s55, 24576
    buffer_load_dwordx4 v11, s[28:31], s55 offen  lds
    v_exp_f32 v207, v207
    v_cvt_pk_bf16_f32 v198, v204, v205
    s_nop 0
    v_cvt_pk_bf16_f32 v199, v206, v207
    v_bfi_b32 v64, v240, 0, v192
    v_and_b32 v192, v240, v192
    v_bfi_b32 v65, v241, 0, v193
    v_and_b32 v193, v241, v193
    v_bfi_b32 v66, v242, 0, v194
    v_and_b32 v194, v242, v194
    v_bfi_b32 v67, v243, 0, v195
    v_and_b32 v195, v243, v195
    v_bfi_b32 v68, v244, 0, v196
    v_and_b32 v196, v244, v196
    v_bfi_b32 v69, v245, 0, v197
    v_and_b32 v197, v245, v197
    v_bfi_b32 v70, v246, 0, v198
    v_and_b32 v198, v246, v198
    v_bfi_b32 v71, v247, 0, v199
    v_and_b32 v199, v247, v199
    s_waitcnt lgkmcnt(3)
    v_mfma_f32_32x32x16_bf16 v[208:223], v[232:235], v[128:131], v[208:223]
    v_exp_f32 v96, v96
    v_exp_f32 v97, v97
    s_cmp_lt_u32 s52, 4
    s_cbranch_scc1 L_nocz
    s_waitcnt vmcnt(4)
    v_mov_b32 v252, 32896
    v_mov_b32 v253, 1
    s_mov_b64 exec, 1
    ds_add_rtn_u32 v15, v252, v253
    s_mov_b64 exec, -1
L_nocz:
    v_exp_f32 v98, v98
    v_exp_f32 v99, v99
    s_waitcnt lgkmcnt(2)
    v_mfma_f32_32x32x16_bf16 v[208:223], v[236:239], v[132:135], v[208:223]
    s_mov_b64 exec, s[96:97]
    ds_read_b128 v[232:235], v8 offset:0
    ds_read_b128 v[236:239], v8 offset:512
    s_mov_b64 exec, -1
    v_cvt_pk_bf16_f32 v96, v96, v97
    v_exp_f32 v100, v100
    v_exp_f32 v101, v101
    v_cvt_pk_bf16_f32 v97, v98, v99
    s_waitcnt lgkmcnt(3)
    v_mfma_f32_32x32x16_bf16 v[208:223], v[224:227], v[112:115], v[208:223]
    v_exp_f32 v102, v102
    s_add_u32 m0, s11, 6144
    s_mov_b32 s55, 49152
    buffer_load_dwordx4 v11, s[28:31], s55 offen  lds
    v_exp_f32 v103, v103
    v_cvt_pk_bf16_f32 v98, v100, v101
    v_exp_f32 v104, v104
    s_waitcnt lgkmcnt(2)
    v_mfma_f32_32x32x16_bf16 v[208:223], v[228:231], v[116:119], v[208:223]
    s_mov_b64 exec, s[96:97]
    ds_read_b128 v[224:227], v6 offset:0
    ds_read_b128 v[228:231], v6 offset:512
    s_mov_b64 exec, -1
    v_exp_f32 v105, v105
    v_cvt_pk_bf16_f32 v99, v102, v103
    s_cmp_lt_u32 s52, 4
    s_cbranch_scc1 L_nofs
    s_waitcnt lgkmcnt(0)
    v_readfirstlane_b32 s55, v15
    s_cmp_lg_u32 s55, 3
    s_cbranch_scc1 L_nofs
    s_lshl_b32 s55, s48, 5
    s_add_u32 s55, s55, s49
    s_lshl_b32 s55, s55, 3
    s_add_u32 s55, s55, 327680
    v_mov_b32 v252, s54
    v_mov_b32 v253, 0
    s_mov_b64 exec, 1
    buffer_store_dword v252, v253, s[36:39], s55 offen sc1
    s_mov_b64 exec, -1
L_nofs:
    v_exp_f32 v106, v106
    v_exp_f32 v107, v107
    s_waitcnt lgkmcnt(3)
    v_mfma_f32_32x32x16_bf16 v[208:223], v[232:235], v[192:195], v[208:223]
    v_cvt_pk_bf16_f32 v100, v104, v105
    v_exp_f32 v108, v108
    v_exp_f32 v109, v109
    v_cvt_pk_bf16_f32 v101, v106, v107
    s_waitcnt lgkmcnt(2)
    v_mfma_f32_32x32x16_bf16 v[208:223], v[236:239], v[196:199], v[208:223]
    s_mov_b64 exec, s[96:97]
    ds_read_b128 v[232:235], v6 offset:8192
    ds_read_b128 v[236:239], v6 offset:8704
    s_mov_b64 exec, -1
    v_exp_f32 v110, v110
    s_add_u32 m0, s11, 4096
    s_mov_b32 s55, 32768
    buffer_load_dwordx4 v11, s[28:31], s55 offen  lds
    v_exp_f32 v111, v111
    v_cvt_pk_bf16_f32 v102, v108, v109
    s_nop 0
    v_cvt_pk_bf16_f32 v103, v110, v111
    s_waitcnt lgkmcnt(3)
    v_mfma_f32_32x32x16_bf16 v[208:223], v[224:227], v[64:67], v[208:223]
    v_exp_f32 v80, v80
    v_exp_f32 v81, v81
    v_exp_f32 v82, v82
    v_exp_f32 v83, v83
    s_waitcnt lgkmcnt(2)
    v_mfma_f32_32x32x16_bf16 v[208:223], v[228:231], v[68:71], v[208:223]
    s_mov_b64 exec, s[96:97]
    ds_read_b128 v[224:227], v6 offset:4096
    ds_read_b128 v[228:231], v6 offset:4608
    s_mov_b64 exec, -1
    v_cvt_pk_bf16_f32 v80, v80, v81
    v_exp_f32 v84, v84
    v_exp_f32 v85, v85
    v_cvt_pk_bf16_f32 v81, v82, v83
    s_waitcnt lgkmcnt(3)
    v_mfma_f32_32x32x16_bf16 v[208:223], v[232:235], v[96:99], v[208:223]
    v_exp_f32 v86, v86
    s_add_u32 m0, s11, 5120
    s_mov_b32 s55, 40960
    buffer_load_dwordx4 v11, s[28:31], s55 offen  lds
    v_exp_f32 v87, v87
    v_cvt_pk_bf16_f32 v82, v84, v85
    v_exp_f32 v88, v88
    s_waitcnt lgkmcnt(2)
    v_mfma_f32_32x32x16_bf16 v[208:223], v[236:239], v[100:103], v[208:223]
    v_exp_f32 v89, v89
    v_cvt_pk_bf16_f32 v83, v86, v87
    v_exp_f32 v90, v90
    v_exp_f32 v91, v91
    v_cvt_pk_bf16_f32 v84, v88, v89
    v_exp_f32 v92, v92
    v_exp_f32 v93, v93
    s_waitcnt lgkmcnt(1)
    v_mfma_f32_32x32x16_bf16 v[208:223], v[224:227], v[80:83], v[208:223]
    v_cvt_pk_bf16_f32 v85, v90, v91
    v_exp_f32 v94, v94
    s_add_u32 m0, s11, 7168
    s_mov_b32 s55, 57344
    buffer_load_dwordx4 v11, s[28:31], s55 offen  lds
    v_exp_f32 v95, v95
    v_cvt_pk_bf16_f32 v86, v92, v93
    s_nop 0
    v_cvt_pk_bf16_f32 v87, v94, v95
    s_nop 0
    s_waitcnt lgkmcnt(0)
    v_mfma_f32_32x32x16_bf16 v[208:223], v[228:231], v[84:87], v[208:223]
    s_nop 7
    s_nop 1
    s_mov_b32 s57, 0x17800000
    s_mov_b32 s58, 0x71800000
    s_movk_i32 s59, 0x1f8
    v_add_f32 v10, v208, v209
    v_add_f32 v9, v210, v211
    v_add_f32 v10, v10, v212
    v_add_f32 v9, v9, v213
    v_add_f32 v10, v10, v214
    v_add_f32 v9, v9, v215
    v_add_f32 v10, v10, v9
    v_cmp_ge_f32 s[8:9], v216, s57
    v_cmp_ge_f32 vcc, s58, v216
    s_and_b64 s[8:9], s[8:9], vcc
    v_cmp_class_f32_e64 vcc, v10, s59
    v_rcp_f32 v10, v216
    s_and_b64 vcc, vcc, s[8:9]
    s_cmp_eq_u64 vcc, -1
    s_cbranch_scc0 L_fb
L_norm:
    v_mul_f32 v208, v208, v10
    v_mul_f32 v209, v209, v10
    v_mul_f32 v210, v210, v10
    v_mul_f32 v211, v211, v10
    v_mul_f32 v212, v212, v10
    v_mul_f32 v213, v213, v10
    v_mul_f32 v214, v214, v10
    v_mul_f32 v215, v215, v10
    v_cvt_pk_bf16_f32 v208, v208, v209
    v_cvt_pk_bf16_f32 v209, v210, v211
    v_cvt_pk_bf16_f32 v210, v212, v213
    v_cvt_pk_bf16_f32 v211, v214, v215
    buffer_store_dwordx4 v[208:211], v4, s[36:39], s53 offen sc1
    s_mov_b32 s60, s99
    s_cmp_lt_u32 s52, 4
    s_cbranch_scc1 L_oproj
    s_setprio 0
    v_bfe_u32 v14, v1, 3, 1
    v_lshlrev_b32 v14, 9, v14
    v_lshrrev_b32 v4, 4, v1
    v_lshl_add_u32 v14, v4, 7, v14
    v_and_b32 v4, 1, v4
    v_xor_b32 v4, v4, v1
    v_and_b32 v4, 7, v4
    v_lshl_add_u32 v14, v4, 4, v14
    s_lshl_b32 s55, s5, 14
    s_lshl_b32 s56, s61, 1
    s_add_u32 s55, s55, s56
    s_add_u32 s55, s55, 8388608
    s_add_u32 m0, s56, 147456
    v_mov_b32 v252, s54
    v_mov_b32 v253, 0
    s_waitcnt vmcnt(0)
    s_mov_b64 exec, 1
    buffer_store_dword v252, v253, s[36:39], s60 offen sc1
    s_mov_b64 exec, -1
    v_mov_b32 v252, 32768
    v_mov_b32 v253, 1
    s_mov_b64 exec, 1
    ds_add_u32 v252, v253
    s_mov_b64 exec, -1
    v_mov_b32 v252, 32768
    s_mov_b32 s8, 0
L_cwf:
    ds_read_b32 v253, v252
    s_add_u32 s8, s8, 1
    s_waitcnt lgkmcnt(0)
    v_readfirstlane_b32 s9, v253
    s_cmp_ge_u32 s8, 0x100000
    s_cbranch_scc1 L_cwfx
    s_cmp_lt_u32 s9, 8
    s_cbranch_scc1 L_cwf
L_cwfx:
    s_setprio 2
    s_cmp_lt_u32 s52, 4
    s_cbranch_scc1 L_nofp
    v_lshlrev_b32 v3, 3, v1
    s_lshr_b32 s57, s61, 2
    s_add_u32 s98, s57, 327680
    buffer_load_dword v2, v3, s[36:39], s98 offen sc1
L_nofp:
    s_waitcnt vmcnt(0)
    v_cmp_ne_u32 vcc, s54, v2
    s_mov_b32 s59, 0
    s_cbranch_vccz L_pa_ok
L_pa:
    s_sleep 8
    buffer_load_dword v2, v3, s[36:39], s98 offen sc1
    s_waitcnt vmcnt(0)
    v_cmp_ne_u32 vcc, s54, v2
    s_add_u32 s59, s59, 1
    s_cbranch_vccz L_pa_ok
    s_cmp_lt_u32 s59, 20000
    s_cbranch_scc1 L_pa
L_pa_ok:
    buffer_load_dwordx4 v14, s[36:39], s55 offen offset:0 sc1 lds
    buffer_load_dwordx4 v14, s[36:39], s55 offen offset:1024 sc1 lds
    buffer_load_dwordx4 v14, s[36:39], s55 offen offset:2048 sc1 lds
    buffer_load_dwordx4 v14, s[36:39], s55 offen offset:3072 sc1 lds
    v_bfe_u32 v9, v1, 2, 2
    v_and_b32 v10, 3, v1
    v_and_b32 v12, 15, v1
    v_lshrrev_b32 v13, 4, v1
    v_lshrrev_b32 v4, 1, v9
    v_mul_u32_u24 v5, 17, v4
    v_lshrrev_b32 v6, 1, v13
    v_lshl_add_u32 v5, v6, 6, v5
    v_and_b32 v6, 1, v13
    v_lshl_add_u32 v5, v6, 3, v5
    v_lshl_add_u32 v5, v10, 1, v5
    v_and_b32 v7, 1, v9
    v_lshlrev_b32 v5, 4, v5
    v_lshl_add_u32 v5, v7, 3, v5
    s_add_u32 s56, s56, 147456
    v_add_u32 v60, s56, v5
    v_xor_b32 v61, 16, v60
    s_lshr_b32 s57, s61, 11
    s_and_b32 s58, s57, 1
    v_and_b32 v8, 2, v13
    v_xor_b32 v8, v8, v12
    v_xor_b32 v11, s58, v13
    v_lshl_or_b32 v8, v11, 4, v8
    v_lshlrev_b32 v8, 3, v8
    v_add_u32 v8, s56, v8
    v_xor_b32 v11, 32, v8
    v_xor_b32 v14, 64, v8
    v_xor_b32 v15, 96, v8
    v_lshrrev_b32 v4, 1, v10
    v_and_b32 v5, 1, v10
    v_mul_u32_u24 v5, 34, v5
    v_or_b32 v4, v4, v5
    v_xor_b32 v5, s57, v9
    v_lshl_or_b32 v4, v5, 2, v4
    v_and_b32 v5, 1, v13
    v_lshl_or_b32 v4, v5, 4, v4
    v_lshl_or_b32 v4, v9, 6, v4
    v_lshlrev_b32 v4, 3, v4
    v_lshl_add_u32 v4, v13, 12, v4
    v_add_u32 v4, 147456, v4
    v_xor_b32 v5, 128, v4
    v_xor_b32 v6, 16, v4
    v_xor_b32 v7, 144, v4
    v_and_b32 v62, 7, v12
    v_lshlrev_b32 v62, 19, v62
    v_lshrrev_b32 v63, 3, v12
    v_lshl_add_u32 v62, v63, 6, v62
    v_lshl_add_u32 v62, v13, 4, v62
    s_lshl_b32 s55, s4, 11
    s_lshr_b32 s56, s61, 4
    s_add_u32 s55, s55, s56
    s_waitcnt vmcnt(0)
    ds_read_b64_tr_b16 v[64:65], v60 offset:0
    ds_read_b64_tr_b16 v[66:67], v60 offset:512
    ds_read_b64_tr_b16 v[68:69], v61 offset:0
    ds_read_b64_tr_b16 v[70:71], v61 offset:512
    ds_read_b64_tr_b16 v[72:73], v60 offset:2048
    ds_read_b64_tr_b16 v[74:75], v60 offset:2560
    ds_read_b64_tr_b16 v[76:77], v61 offset:2048
    ds_read_b64_tr_b16 v[78:79], v61 offset:2560
    s_waitcnt lgkmcnt(6)
    v_mfma_f32_16x16x32_bf16 v[80:83], v[64:67], v[16:19], 0
    v_mfma_f32_16x16x32_bf16 v[84:87], v[64:67], v[20:23], 0
    s_waitcnt lgkmcnt(4)
    v_mfma_f32_16x16x32_bf16 v[88:91], v[68:71], v[16:19], 0
    v_mfma_f32_16x16x32_bf16 v[92:95], v[68:71], v[20:23], 0
    s_waitcnt lgkmcnt(2)
    v_mfma_f32_16x16x32_bf16 v[96:99], v[72:75], v[16:19], 0
    v_mfma_f32_16x16x32_bf16 v[100:103], v[72:75], v[20:23], 0
    s_waitcnt lgkmcnt(0)
    v_mfma_f32_16x16x32_bf16 v[104:107], v[76:79], v[16:19], 0
    v_mfma_f32_16x16x32_bf16 v[108:111], v[76:79], v[20:23], 0
    s_nop 1
    v_pk_mul_f32 v[164:165], v[80:81], v[24:25]
    v_pk_mul_f32 v[166:167], v[84:85], v[24:25]
    v_pk_fma_f32 v[164:165], v[84:85], v[32:33], v[164:165]
    v_pk_fma_f32 v[166:167], v[80:81], v[32:33], v[166:167] neg_lo:[1,0,0] neg_hi:[1,0,0]
    v_cvt_pk_bf16_f32 v112, v164, v166
    v_cvt_pk_bf16_f32 v116, v165, v167
    v_pk_mul_f32 v[168:169], v[82:83], v[26:27]
    v_pk_mul_f32 v[170:171], v[86:87], v[26:27]
    v_pk_fma_f32 v[168:169], v[86:87], v[34:35], v[168:169]
    v_pk_fma_f32 v[170:171], v[82:83], v[34:35], v[170:171] neg_lo:[1,0,0] neg_hi:[1,0,0]
    v_cvt_pk_bf16_f32 v113, v168, v170
    v_cvt_pk_bf16_f32 v117, v169, v171
    v_pk_mul_f32 v[164:165], v[88:89], v[28:29]
    v_pk_mul_f32 v[166:167], v[92:93], v[28:29]
    v_pk_fma_f32 v[164:165], v[92:93], v[36:37], v[164:165]
    v_pk_fma_f32 v[166:167], v[88:89], v[36:37], v[166:167] neg_lo:[1,0,0] neg_hi:[1,0,0]
    v_cvt_pk_bf16_f32 v114, v164, v166
    v_cvt_pk_bf16_f32 v118, v165, v167
    v_pk_mul_f32 v[168:169], v[90:91], v[30:31]
    v_pk_mul_f32 v[170:171], v[94:95], v[30:31]
    v_pk_fma_f32 v[168:169], v[94:95], v[38:39], v[168:169]
    v_pk_fma_f32 v[170:171], v[90:91], v[38:39], v[170:171] neg_lo:[1,0,0] neg_hi:[1,0,0]
    v_cvt_pk_bf16_f32 v115, v168, v170
    v_cvt_pk_bf16_f32 v119, v169, v171
    s_nop 1
    v_mfma_f32_16x16x32_bf16 v[132:135], v[112:115], v[40:43], 0
    v_mfma_f32_16x16x32_bf16 v[136:139], v[112:115], v[44:47], 0
    v_mfma_f32_16x16x32_bf16 v[140:143], v[116:119], v[48:51], 0
    v_mfma_f32_16x16x32_bf16 v[144:147], v[116:119], v[52:55], 0
    v_pk_mul_f32 v[164:165], v[96:97], v[24:25]
    v_pk_mul_f32 v[166:167], v[100:101], v[24:25]
    v_pk_fma_f32 v[164:165], v[100:101], v[32:33], v[164:165]
    v_pk_fma_f32 v[166:167], v[96:97], v[32:33], v[166:167] neg_lo:[1,0,0] neg_hi:[1,0,0]
    v_cvt_pk_bf16_f32 v120, v164, v166
    v_cvt_pk_bf16_f32 v124, v165, v167
    v_pk_mul_f32 v[168:169], v[98:99], v[26:27]
    v_pk_mul_f32 v[170:171], v[102:103], v[26:27]
    v_pk_fma_f32 v[168:169], v[102:103], v[34:35], v[168:169]
    v_pk_fma_f32 v[170:171], v[98:99], v[34:35], v[170:171] neg_lo:[1,0,0] neg_hi:[1,0,0]
    v_cvt_pk_bf16_f32 v121, v168, v170
    v_cvt_pk_bf16_f32 v125, v169, v171
    v_pk_mul_f32 v[164:165], v[104:105], v[28:29]
    v_pk_mul_f32 v[166:167], v[108:109], v[28:29]
    v_pk_fma_f32 v[164:165], v[108:109], v[36:37], v[164:165]
    v_pk_fma_f32 v[166:167], v[104:105], v[36:37], v[166:167] neg_lo:[1,0,0] neg_hi:[1,0,0]
    v_cvt_pk_bf16_f32 v122, v164, v166
    v_cvt_pk_bf16_f32 v126, v165, v167
    v_pk_mul_f32 v[168:169], v[106:107], v[30:31]
    v_pk_mul_f32 v[170:171], v[110:111], v[30:31]
    v_pk_fma_f32 v[168:169], v[110:111], v[38:39], v[168:169]
    v_pk_fma_f32 v[170:171], v[106:107], v[38:39], v[170:171] neg_lo:[1,0,0] neg_hi:[1,0,0]
    v_cvt_pk_bf16_f32 v123, v168, v170
    v_cvt_pk_bf16_f32 v127, v169, v171
    s_nop 1
    v_mfma_f32_16x16x32_bf16 v[148:151], v[120:123], v[40:43], 0
    v_mfma_f32_16x16x32_bf16 v[152:155], v[120:123], v[44:47], 0
    v_mfma_f32_16x16x32_bf16 v[156:159], v[124:127], v[48:51], 0
    v_mfma_f32_16x16x32_bf16 v[160:163], v[124:127], v[52:55], 0
    v_cvt_pk_bf16_f32 v132, v132, v133
    v_cvt_pk_bf16_f32 v133, v134, v135
    ds_write_b64 v8, v[132:133] offset:0
    v_cvt_pk_bf16_f32 v136, v136, v137
    v_cvt_pk_bf16_f32 v137, v138, v139
    ds_write_b64 v11, v[136:137] offset:512
    v_cvt_pk_bf16_f32 v140, v140, v141
    v_cvt_pk_bf16_f32 v141, v142, v143
    ds_write_b64 v14, v[140:141] offset:1024
    v_cvt_pk_bf16_f32 v144, v144, v145
    v_cvt_pk_bf16_f32 v145, v146, v147
    ds_write_b64 v15, v[144:145] offset:1536
    s_nop 1
    v_cvt_pk_bf16_f32 v148, v148, v149
    v_cvt_pk_bf16_f32 v149, v150, v151
    ds_write_b64 v8, v[148:149] offset:2048
    v_cvt_pk_bf16_f32 v152, v152, v153
    v_cvt_pk_bf16_f32 v153, v154, v155
    ds_write_b64 v11, v[152:153] offset:2560
    v_cvt_pk_bf16_f32 v156, v156, v157
    v_cvt_pk_bf16_f32 v157, v158, v159
    ds_write_b64 v14, v[156:157] offset:3072
    v_cvt_pk_bf16_f32 v160, v160, v161
    v_cvt_pk_bf16_f32 v161, v162, v163
    ds_write_b64 v15, v[160:161] offset:3584
    s_waitcnt lgkmcnt(0)
    v_mov_b32 v252, 32832
    v_mov_b32 v253, 1
    s_mov_b64 exec, 1
    ds_add_u32 v252, v253
    s_mov_b64 exec, -1
    v_mov_b32 v252, 32832
    s_mov_b32 s8, 0
L_cwa:
    ds_read_b32 v253, v252
    s_add_u32 s8, s8, 1
    s_waitcnt lgkmcnt(0)
    v_readfirstlane_b32 s9, v253
    s_cmp_ge_u32 s8, 0x100000
    s_cbranch_scc1 L_cwax
    s_cmp_lt_u32 s9, 4
    s_cbranch_scc1 L_cwa
L_cwax:
    ds_read_b64_tr_b16 v[64:65], v4 offset:0
    ds_read_b64_tr_b16 v[66:67], v4 offset:2048
    ds_read_b64_tr_b16 v[68:69], v5 offset:0
    ds_read_b64_tr_b16 v[70:71], v5 offset:2048
    ds_read_b64_tr_b16 v[72:73], v6 offset:0
    ds_read_b64_tr_b16 v[74:75], v6 offset:2048
    ds_read_b64_tr_b16 v[76:77], v7 offset:0
    ds_read_b64_tr_b16 v[78:79], v7 offset:2048
    s_cmp_lg_u32 s2, 0
    s_cbranch_scc1 L_noep
    s_cmp_lg_u32 s52, 4
    s_cbranch_scc1 L_noep
    v_mov_b32 v252, s54
    v_mov_b32 v253, 0
    s_mov_b64 exec, 1
    buffer_store_dword v252, v253, s[36:39], 0 offen sc1
    s_mov_b64 exec, -1
L_noep:
    s_waitcnt lgkmcnt(6)
    v_mfma_f32_16x16x32_bf16 v[80:83], v[64:67], v[56:59], 0
    s_waitcnt lgkmcnt(4)
    v_mfma_f32_16x16x32_bf16 v[84:87], v[68:71], v[56:59], 0
    s_waitcnt lgkmcnt(2)
    v_mfma_f32_16x16x32_bf16 v[88:91], v[72:75], v[56:59], 0
    s_waitcnt lgkmcnt(0)
    v_mfma_f32_16x16x32_bf16 v[92:95], v[76:79], v[56:59], 0
    s_nop 7
    v_cvt_pk_bf16_f32 v80, v80, v81
    v_cvt_pk_bf16_f32 v81, v82, v83
    v_cvt_pk_bf16_f32 v82, v84, v85
    v_cvt_pk_bf16_f32 v83, v86, v87
    v_cvt_pk_bf16_f32 v88, v88, v89
    v_cvt_pk_bf16_f32 v89, v90, v91
    v_cvt_pk_bf16_f32 v90, v92, v93
    v_cvt_pk_bf16_f32 v91, v94, v95
    v_mov_b32 v84, v88
    v_mov_b32 v85, v89
    v_mov_b32 v86, v90
    v_mov_b32 v87, v91
    v_mov_b32_dpp v88, v80 row_ror:8 row_mask:0xf bank_mask:0x3
    v_mov_b32_dpp v89, v81 row_ror:8 row_mask:0xf bank_mask:0x3
    v_mov_b32_dpp v90, v82 row_ror:8 row_mask:0xf bank_mask:0x3
    v_mov_b32_dpp v91, v83 row_ror:8 row_mask:0xf bank_mask:0x3
    v_mov_b32_dpp v80, v84 row_ror:8 row_mask:0xf bank_mask:0xc
    v_mov_b32_dpp v81, v85 row_ror:8 row_mask:0xf bank_mask:0xc
    v_mov_b32_dpp v82, v86 row_ror:8 row_mask:0xf bank_mask:0xc
    v_mov_b32_dpp v83, v87 row_ror:8 row_mask:0xf bank_mask:0xc
    buffer_store_dwordx4 v[80:83], v62, s[32:35], s55 offen offset:0 sc1 nt
    buffer_store_dwordx4 v[88:91], v62, s[32:35], s55 offen offset:512 sc1 nt
    s_branch L_fin
L_oproj:
    s_lshl_b32 s4, s48, 2
    s_and_b32 s55, s49, 3
    s_add_u32 s4, s4, s55
    v_bfe_u32 v9, v1, 2, 2
    v_and_b32 v10, 3, v1
    v_lshrrev_b32 v13, 4, v1
    v_lshrrev_b32 v4, 1, v13
    v_and_b32 v5, 1, v13
    v_lshlrev_b32 v4, 4, v4
    v_lshl_add_u32 v4, v5, 2, v4
    v_add_u32 v4, v4, v9
    v_lshlrev_b32 v4, 7, v4
    v_lshrrev_b32 v6, 1, v9
    v_lshl_add_u32 v6, v5, 1, v6
    v_lshlrev_b32 v6, 1, v6
    v_lshrrev_b32 v7, 1, v10
    v_xor_b32 v6, v6, v7
    v_lshl_add_u32 v4, v6, 4, v4
    v_and_b32 v7, 1, v10
    v_lshl_add_u32 v4, v7, 3, v4
    v_add_u32 v4, 65536, v4
    v_xor_b32 v5, 32, v4
    v_xor_b32 v6, 64, v4
    v_xor_b32 v7, 96, v4
    s_lshl_b32 s55, s4, 2
    s_add_u32 s55, s55, s52
    s_lshl_b32 s56, s55, 14
    s_add_u32 s56, s56, 5242880
    v_lshlrev_b32 v8, 4, v1
    v_add_u32 v8, s56, v8
    s_lshr_b32 s56, s55, 1
    s_lshl_b32 s56, s56, 9
    s_add_u32 s59, s56, 196608
    v_lshlrev_b32 v15, 4, v1
    s_lshl_b32 s55, s55, 15
    s_lshr_b32 s56, s49, 2
    s_add_u32 s56, s56, 0
    s_and_b32 s56, s56, 7
    s_lshl_b32 s56, s56, 7
    s_add_u32 s55, s55, s56
    s_add_u32 s4, s55, 1024
    v_and_b32 v12, 7, v1
    v_lshlrev_b32 v12, 11, v12
    v_bfe_u32 v14, v1, 3, 1
    v_lshl_add_u32 v12, v14, 6, v12
    v_and_b32 v14, 1, v13
    v_lshl_add_u32 v12, v14, 5, v12
    v_lshrrev_b32 v14, 1, v13
    v_lshl_add_u32 v12, v14, 4, v12
    v_mov_b32 v252, s54
    v_mov_b32 v253, 0
    s_waitcnt vmcnt(0)
    s_mov_b64 exec, 1
    buffer_store_dword v252, v253, s[36:39], s60 offen sc1
    s_mov_b64 exec, -1
    v_mov_b32 v252, 32768
    v_mov_b32 v253, 1
    s_mov_b64 exec, 1
    ds_add_u32 v252, v253
    s_mov_b64 exec, -1
    s_mov_b32 s60, 0
    v_mov_b32 v252, 32768
    s_mov_b32 s8, 0
L_cww:
    ds_read_b32 v253, v252
    s_add_u32 s8, s8, 1
    s_waitcnt lgkmcnt(0)
    v_readfirstlane_b32 s9, v253
    s_cmp_ge_u32 s8, 0x100000
    s_cbranch_scc1 L_cwwx
    s_cmp_lt_u32 s9, 8
    s_cbranch_scc1 L_cww
L_cwwx:
L_oredo:
    ds_read_b64_tr_b16 v[128:129], v4 offset:0
    ds_read_b64_tr_b16 v[130:131], v4 offset:1024
    ds_read_b64_tr_b16 v[132:133], v5 offset:0
    ds_read_b64_tr_b16 v[134:135], v5 offset:1024
    ds_read_b64_tr_b16 v[136:137], v6 offset:0
    ds_read_b64_tr_b16 v[138:139], v6 offset:1024
    ds_read_b64_tr_b16 v[140:141], v7 offset:0
    ds_read_b64_tr_b16 v[142:143], v7 offset:1024
    s_waitcnt lgkmcnt(7)
    ds_read_b64_tr_b16 v[144:145], v4 offset:4096
    ds_read_b64_tr_b16 v[146:147], v4 offset:5120
    ds_read_b64_tr_b16 v[148:149], v5 offset:4096
    ds_read_b64_tr_b16 v[150:151], v5 offset:5120
    ds_read_b64_tr_b16 v[152:153], v6 offset:4096
    ds_read_b64_tr_b16 v[154:155], v6 offset:5120
    ds_read_b64_tr_b16 v[156:157], v7 offset:4096
    ds_read_b64_tr_b16 v[158:159], v7 offset:5120
    s_waitcnt lgkmcnt(7)
    ds_read_b64_tr_b16 v[160:161], v4 offset:8192
    ds_read_b64_tr_b16 v[162:163], v4 offset:9216
    ds_read_b64_tr_b16 v[164:165], v5 offset:8192
    ds_read_b64_tr_b16 v[166:167], v5 offset:9216
    ds_read_b64_tr_b16 v[168:169], v6 offset:8192
    ds_read_b64_tr_b16 v[170:171], v6 offset:9216
    ds_read_b64_tr_b16 v[172:173], v7 offset:8192
    ds_read_b64_tr_b16 v[174:175], v7 offset:9216
    s_waitcnt lgkmcnt(7)
    ds_read_b64_tr_b16 v[176:177], v4 offset:12288
    ds_read_b64_tr_b16 v[178:179], v4 offset:13312
    ds_read_b64_tr_b16 v[180:181], v5 offset:12288
    ds_read_b64_tr_b16 v[182:183], v5 offset:13312
    ds_read_b64_tr_b16 v[184:185], v6 offset:12288
    ds_read_b64_tr_b16 v[186:187], v6 offset:13312
    ds_read_b64_tr_b16 v[188:189], v7 offset:12288
    ds_read_b64_tr_b16 v[190:191], v7 offset:13312
    s_waitcnt lgkmcnt(7)
    ds_read_b64_tr_b16 v[192:193], v4 offset:16384
    ds_read_b64_tr_b16 v[194:195], v4 offset:17408
    ds_read_b64_tr_b16 v[196:197], v5 offset:16384
    ds_read_b64_tr_b16 v[198:199], v5 offset:17408
    ds_read_b64_tr_b16 v[200:201], v6 offset:16384
    ds_read_b64_tr_b16 v[202:203], v6 offset:17408
    ds_read_b64_tr_b16 v[204:205], v7 offset:16384
    ds_read_b64_tr_b16 v[206:207], v7 offset:17408
    s_waitcnt lgkmcnt(7)
    ds_read_b64_tr_b16 v[208:209], v4 offset:20480
    ds_read_b64_tr_b16 v[210:211], v4 offset:21504
    ds_read_b64_tr_b16 v[212:213], v5 offset:20480
    ds_read_b64_tr_b16 v[214:215], v5 offset:21504
    ds_read_b64_tr_b16 v[216:217], v6 offset:20480
    ds_read_b64_tr_b16 v[218:219], v6 offset:21504
    ds_read_b64_tr_b16 v[220:221], v7 offset:20480
    ds_read_b64_tr_b16 v[222:223], v7 offset:21504
    s_waitcnt lgkmcnt(7)
    ds_read_b64_tr_b16 v[224:225], v4 offset:24576
    ds_read_b64_tr_b16 v[226:227], v4 offset:25600
    ds_read_b64_tr_b16 v[228:229], v5 offset:24576
    ds_read_b64_tr_b16 v[230:231], v5 offset:25600
    ds_read_b64_tr_b16 v[232:233], v6 offset:24576
    ds_read_b64_tr_b16 v[234:235], v6 offset:25600
    ds_read_b64_tr_b16 v[236:237], v7 offset:24576
    ds_read_b64_tr_b16 v[238:239], v7 offset:25600
    s_waitcnt lgkmcnt(7)
    ds_read_b64_tr_b16 v[32:33], v4 offset:28672
    ds_read_b64_tr_b16 v[34:35], v4 offset:29696
    ds_read_b64_tr_b16 v[36:37], v5 offset:28672
    ds_read_b64_tr_b16 v[38:39], v5 offset:29696
    ds_read_b64_tr_b16 v[40:41], v6 offset:28672
    ds_read_b64_tr_b16 v[42:43], v6 offset:29696
    ds_read_b64_tr_b16 v[44:45], v7 offset:28672
    ds_read_b64_tr_b16 v[46:47], v7 offset:29696
    s_waitcnt lgkmcnt(7)
    ds_read_b64_tr_b16 v[48:49], v4 offset:32768
    ds_read_b64_tr_b16 v[50:51], v4 offset:33792
    ds_read_b64_tr_b16 v[52:53], v5 offset:32768
    ds_read_b64_tr_b16 v[54:55], v5 offset:33792
    ds_read_b64_tr_b16 v[56:57], v6 offset:32768
    ds_read_b64_tr_b16 v[58:59], v6 offset:33792
    ds_read_b64_tr_b16 v[60:61], v7 offset:32768
    ds_read_b64_tr_b16 v[62:63], v7 offset:33792
    s_mov_b32 exec_hi, 0
    s_mov_b32 s58, 0
    buffer_load_dword v10, v15, s[36:39], s59 offen sc1
L_p2:
    s_waitcnt vmcnt(0)
    v_cmp_ne_u32 vcc, s54, v10
    s_add_u32 s58, s58, 1
    s_cbranch_vccz L_p2ok
    buffer_load_dword v10, v15, s[36:39], s59 offen sc1
    s_cmp_lt_u32 s58, 20000
    s_cbranch_scc1 L_p2
L_p2ok:
    s_mov_b64 exec, -1
    s_mov_b32 s56, 4096
    s_mov_b32 s57, 8192
    s_mov_b32 s58, 12288
    buffer_load_dwordx4 v[64:67], v8, s[36:39], 0 offen offset:0 sc1
    buffer_load_dwordx4 v[68:71], v8, s[36:39], 0 offen offset:1024 sc1
    buffer_load_dwordx4 v[72:75], v8, s[36:39], 0 offen offset:2048 sc1
    buffer_load_dwordx4 v[76:79], v8, s[36:39], 0 offen offset:3072 sc1
    buffer_load_dwordx4 v[80:83], v8, s[36:39], s56 offen offset:0 sc1
    buffer_load_dwordx4 v[84:87], v8, s[36:39], s56 offen offset:1024 sc1
    buffer_load_dwordx4 v[88:91], v8, s[36:39], s56 offen offset:2048 sc1
    buffer_load_dwordx4 v[92:95], v8, s[36:39], s56 offen offset:3072 sc1
    buffer_load_dwordx4 v[96:99], v8, s[36:39], s57 offen offset:0 sc1
    buffer_load_dwordx4 v[100:103], v8, s[36:39], s57 offen offset:1024 sc1
    buffer_load_dwordx4 v[104:107], v8, s[36:39], s57 offen offset:2048 sc1
    buffer_load_dwordx4 v[108:111], v8, s[36:39], s57 offen offset:3072 sc1
    buffer_load_dwordx4 v[112:115], v8, s[36:39], s58 offen offset:0 sc1
    buffer_load_dwordx4 v[116:119], v8, s[36:39], s58 offen offset:1024 sc1
    buffer_load_dwordx4 v[120:123], v8, s[36:39], s58 offen offset:2048 sc1
    buffer_load_dwordx4 v[124:127], v8, s[36:39], s58 offen offset:3072 sc1
L_ogo:
    s_waitcnt vmcnt(15) lgkmcnt(0)
    v_mfma_f32_16x16x32_bf16 v[16:19], v[128:131], v[64:67], 0
    v_mfma_f32_16x16x32_bf16 v[20:23], v[132:135], v[64:67], 0
    v_mfma_f32_16x16x32_bf16 v[24:27], v[136:139], v[64:67], 0
    v_mfma_f32_16x16x32_bf16 v[28:31], v[140:143], v[64:67], 0
    ds_read_b64_tr_b16 v[128:129], v4 offset:36864
    ds_read_b64_tr_b16 v[130:131], v4 offset:37888
    ds_read_b64_tr_b16 v[132:133], v5 offset:36864
    ds_read_b64_tr_b16 v[134:135], v5 offset:37888
    ds_read_b64_tr_b16 v[136:137], v6 offset:36864
    ds_read_b64_tr_b16 v[138:139], v6 offset:37888
    ds_read_b64_tr_b16 v[140:141], v7 offset:36864
    ds_read_b64_tr_b16 v[142:143], v7 offset:37888
    s_waitcnt vmcnt(14)
    v_mfma_f32_16x16x32_bf16 v[16:19], v[144:147], v[68:71], v[16:19]
    v_mfma_f32_16x16x32_bf16 v[20:23], v[148:151], v[68:71], v[20:23]
    v_mfma_f32_16x16x32_bf16 v[24:27], v[152:155], v[68:71], v[24:27]
    v_mfma_f32_16x16x32_bf16 v[28:31], v[156:159], v[68:71], v[28:31]
    s_waitcnt lgkmcnt(7)
    ds_read_b64_tr_b16 v[144:145], v4 offset:40960
    ds_read_b64_tr_b16 v[146:147], v4 offset:41984
    ds_read_b64_tr_b16 v[148:149], v5 offset:40960
    ds_read_b64_tr_b16 v[150:151], v5 offset:41984
    ds_read_b64_tr_b16 v[152:153], v6 offset:40960
    ds_read_b64_tr_b16 v[154:155], v6 offset:41984
    ds_read_b64_tr_b16 v[156:157], v7 offset:40960
    ds_read_b64_tr_b16 v[158:159], v7 offset:41984
    s_waitcnt vmcnt(13)
    v_mfma_f32_16x16x32_bf16 v[16:19], v[160:163], v[72:75], v[16:19]
    v_mfma_f32_16x16x32_bf16 v[20:23], v[164:167], v[72:75], v[20:23]
    v_mfma_f32_16x16x32_bf16 v[24:27], v[168:171], v[72:75], v[24:27]
    v_mfma_f32_16x16x32_bf16 v[28:31], v[172:175], v[72:75], v[28:31]
    s_waitcnt lgkmcnt(7)
    ds_read_b64_tr_b16 v[160:161], v4 offset:45056
    ds_read_b64_tr_b16 v[162:163], v4 offset:46080
    ds_read_b64_tr_b16 v[164:165], v5 offset:45056
    ds_read_b64_tr_b16 v[166:167], v5 offset:46080
    ds_read_b64_tr_b16 v[168:169], v6 offset:45056
    ds_read_b64_tr_b16 v[170:171], v6 offset:46080
    ds_read_b64_tr_b16 v[172:173], v7 offset:45056
    ds_read_b64_tr_b16 v[174:175], v7 offset:46080
    s_waitcnt vmcnt(12)
    v_mfma_f32_16x16x32_bf16 v[16:19], v[176:179], v[76:79], v[16:19]
    v_mfma_f32_16x16x32_bf16 v[20:23], v[180:183], v[76:79], v[20:23]
    v_mfma_f32_16x16x32_bf16 v[24:27], v[184:187], v[76:79], v[24:27]
    v_mfma_f32_16x16x32_bf16 v[28:31], v[188:191], v[76:79], v[28:31]
    s_waitcnt lgkmcnt(7)
    ds_read_b64_tr_b16 v[176:177], v4 offset:49152
    ds_read_b64_tr_b16 v[178:179], v4 offset:50176
    ds_read_b64_tr_b16 v[180:181], v5 offset:49152
    ds_read_b64_tr_b16 v[182:183], v5 offset:50176
    ds_read_b64_tr_b16 v[184:185], v6 offset:49152
    ds_read_b64_tr_b16 v[186:187], v6 offset:50176
    ds_read_b64_tr_b16 v[188:189], v7 offset:49152
    ds_read_b64_tr_b16 v[190:191], v7 offset:50176
    s_waitcnt vmcnt(11)
    v_mfma_f32_16x16x32_bf16 v[16:19], v[192:195], v[80:83], v[16:19]
    v_mfma_f32_16x16x32_bf16 v[20:23], v[196:199], v[80:83], v[20:23]
    v_mfma_f32_16x16x32_bf16 v[24:27], v[200:203], v[80:83], v[24:27]
    v_mfma_f32_16x16x32_bf16 v[28:31], v[204:207], v[80:83], v[28:31]
    s_waitcnt lgkmcnt(7)
    ds_read_b64_tr_b16 v[192:193], v4 offset:53248
    ds_read_b64_tr_b16 v[194:195], v4 offset:54272
    ds_read_b64_tr_b16 v[196:197], v5 offset:53248
    ds_read_b64_tr_b16 v[198:199], v5 offset:54272
    ds_read_b64_tr_b16 v[200:201], v6 offset:53248
    ds_read_b64_tr_b16 v[202:203], v6 offset:54272
    ds_read_b64_tr_b16 v[204:205], v7 offset:53248
    ds_read_b64_tr_b16 v[206:207], v7 offset:54272
    s_waitcnt vmcnt(10)
    v_mfma_f32_16x16x32_bf16 v[16:19], v[208:211], v[84:87], v[16:19]
    v_mfma_f32_16x16x32_bf16 v[20:23], v[212:215], v[84:87], v[20:23]
    v_mfma_f32_16x16x32_bf16 v[24:27], v[216:219], v[84:87], v[24:27]
    v_mfma_f32_16x16x32_bf16 v[28:31], v[220:223], v[84:87], v[28:31]
    s_waitcnt lgkmcnt(7)
    ds_read_b64_tr_b16 v[208:209], v4 offset:57344
    ds_read_b64_tr_b16 v[210:211], v4 offset:58368
    ds_read_b64_tr_b16 v[212:213], v5 offset:57344
    ds_read_b64_tr_b16 v[214:215], v5 offset:58368
    ds_read_b64_tr_b16 v[216:217], v6 offset:57344
    ds_read_b64_tr_b16 v[218:219], v6 offset:58368
    ds_read_b64_tr_b16 v[220:221], v7 offset:57344
    ds_read_b64_tr_b16 v[222:223], v7 offset:58368
    s_waitcnt vmcnt(9)
    v_mfma_f32_16x16x32_bf16 v[16:19], v[224:227], v[88:91], v[16:19]
    v_mfma_f32_16x16x32_bf16 v[20:23], v[228:231], v[88:91], v[20:23]
    v_mfma_f32_16x16x32_bf16 v[24:27], v[232:235], v[88:91], v[24:27]
    v_mfma_f32_16x16x32_bf16 v[28:31], v[236:239], v[88:91], v[28:31]
    s_waitcnt lgkmcnt(7)
    ds_read_b64_tr_b16 v[224:225], v4 offset:61440
    ds_read_b64_tr_b16 v[226:227], v4 offset:62464
    ds_read_b64_tr_b16 v[228:229], v5 offset:61440
    ds_read_b64_tr_b16 v[230:231], v5 offset:62464
    ds_read_b64_tr_b16 v[232:233], v6 offset:61440
    ds_read_b64_tr_b16 v[234:235], v6 offset:62464
    ds_read_b64_tr_b16 v[236:237], v7 offset:61440
    ds_read_b64_tr_b16 v[238:239], v7 offset:62464
    s_waitcnt vmcnt(8)
    v_mfma_f32_16x16x32_bf16 v[16:19], v[32:35], v[92:95], v[16:19]
    v_mfma_f32_16x16x32_bf16 v[20:23], v[36:39], v[92:95], v[20:23]
    v_mfma_f32_16x16x32_bf16 v[24:27], v[40:43], v[92:95], v[24:27]
    v_mfma_f32_16x16x32_bf16 v[28:31], v[44:47], v[92:95], v[28:31]
    s_waitcnt vmcnt(7)
    v_mfma_f32_16x16x32_bf16 v[16:19], v[48:51], v[96:99], v[16:19]
    v_mfma_f32_16x16x32_bf16 v[20:23], v[52:55], v[96:99], v[20:23]
    v_mfma_f32_16x16x32_bf16 v[24:27], v[56:59], v[96:99], v[24:27]
    v_mfma_f32_16x16x32_bf16 v[28:31], v[60:63], v[96:99], v[28:31]
    s_waitcnt vmcnt(6) lgkmcnt(0)
    v_mfma_f32_16x16x32_bf16 v[16:19], v[128:131], v[100:103], v[16:19]
    v_mfma_f32_16x16x32_bf16 v[20:23], v[132:135], v[100:103], v[20:23]
    v_mfma_f32_16x16x32_bf16 v[24:27], v[136:139], v[100:103], v[24:27]
    v_mfma_f32_16x16x32_bf16 v[28:31], v[140:143], v[100:103], v[28:31]
    s_waitcnt vmcnt(5)
    v_mfma_f32_16x16x32_bf16 v[16:19], v[144:147], v[104:107], v[16:19]
    v_mfma_f32_16x16x32_bf16 v[20:23], v[148:151], v[104:107], v[20:23]
    v_mfma_f32_16x16x32_bf16 v[24:27], v[152:155], v[104:107], v[24:27]
    v_mfma_f32_16x16x32_bf16 v[28:31], v[156:159], v[104:107], v[28:31]
    s_waitcnt vmcnt(4)
    v_mfma_f32_16x16x32_bf16 v[16:19], v[160:163], v[108:111], v[16:19]
    v_mfma_f32_16x16x32_bf16 v[20:23], v[164:167], v[108:111], v[20:23]
    v_mfma_f32_16x16x32_bf16 v[24:27], v[168:171], v[108:111], v[24:27]
    v_mfma_f32_16x16x32_bf16 v[28:31], v[172:175], v[108:111], v[28:31]
    s_waitcnt vmcnt(3)
    v_mfma_f32_16x16x32_bf16 v[16:19], v[176:179], v[112:115], v[16:19]
    v_mfma_f32_16x16x32_bf16 v[20:23], v[180:183], v[112:115], v[20:23]
    v_mfma_f32_16x16x32_bf16 v[24:27], v[184:187], v[112:115], v[24:27]
    v_mfma_f32_16x16x32_bf16 v[28:31], v[188:191], v[112:115], v[28:31]
    s_waitcnt vmcnt(2)
    v_mfma_f32_16x16x32_bf16 v[16:19], v[192:195], v[116:119], v[16:19]
    v_mfma_f32_16x16x32_bf16 v[20:23], v[196:199], v[116:119], v[20:23]
    v_mfma_f32_16x16x32_bf16 v[24:27], v[200:203], v[116:119], v[24:27]
    v_mfma_f32_16x16x32_bf16 v[28:31], v[204:207], v[116:119], v[28:31]
    s_waitcnt vmcnt(1)
    v_mfma_f32_16x16x32_bf16 v[16:19], v[208:211], v[120:123], v[16:19]
    v_mfma_f32_16x16x32_bf16 v[20:23], v[212:215], v[120:123], v[20:23]
    v_mfma_f32_16x16x32_bf16 v[24:27], v[216:219], v[120:123], v[24:27]
    v_mfma_f32_16x16x32_bf16 v[28:31], v[220:223], v[120:123], v[28:31]
    s_waitcnt vmcnt(0)
    v_mfma_f32_16x16x32_bf16 v[16:19], v[224:227], v[124:127], v[16:19]
    v_mfma_f32_16x16x32_bf16 v[20:23], v[228:231], v[124:127], v[20:23]
    v_mfma_f32_16x16x32_bf16 v[24:27], v[232:235], v[124:127], v[24:27]
    v_mfma_f32_16x16x32_bf16 v[28:31], v[236:239], v[124:127], v[28:31]
    s_nop 4
    s_nop 2
    v_cvt_pk_bf16_f32 v16, v16, v17
    v_cvt_pk_bf16_f32 v17, v18, v19
    v_cvt_pk_bf16_f32 v18, v20, v21
    v_cvt_pk_bf16_f32 v19, v22, v23
    v_cvt_pk_bf16_f32 v20, v24, v25
    v_cvt_pk_bf16_f32 v21, v26, v27
    v_cvt_pk_bf16_f32 v22, v28, v29
    v_cvt_pk_bf16_f32 v23, v30, v31
    s_nop 1
    v_permlane16_swap_b32 v16, v18
    v_permlane16_swap_b32 v17, v19
    v_permlane16_swap_b32 v20, v22
    v_permlane16_swap_b32 v21, v23
    s_add_u32 s55, s4, 16384
    v_mov_b32 v24, v20
    v_mov_b32 v25, v21
    v_mov_b32 v26, v22
    v_mov_b32 v27, v23
    v_mov_b32_dpp v20, v16 row_ror:8 row_mask:0xf bank_mask:0x3
    v_mov_b32_dpp v21, v17 row_ror:8 row_mask:0xf bank_mask:0x3
    v_mov_b32_dpp v22, v18 row_ror:8 row_mask:0xf bank_mask:0x3
    v_mov_b32_dpp v23, v19 row_ror:8 row_mask:0xf bank_mask:0x3
    v_mov_b32_dpp v16, v24 row_ror:8 row_mask:0xf bank_mask:0xc
    v_mov_b32_dpp v17, v25 row_ror:8 row_mask:0xf bank_mask:0xc
    v_mov_b32_dpp v18, v26 row_ror:8 row_mask:0xf bank_mask:0xc
    v_mov_b32_dpp v19, v27 row_ror:8 row_mask:0xf bank_mask:0xc
    buffer_store_dwordx4 v[16:19], v12, s[32:35], s4 offen sc1 nt
    buffer_store_dwordx4 v[20:23], v12, s[32:35], s55 offen sc1 nt
L_fin:
L_end:
    s_endpgm
L_miss7:
    s_nop 7
    v_mov_b32 v208, 0xf149f2ca
    v_mov_b32 v209, v208
    v_mov_b32 v210, v208
    v_mov_b32 v211, v208
    v_mov_b32 v212, v208
    v_mov_b32 v213, v208
    v_mov_b32 v214, v208
    v_mov_b32 v215, v208
    v_mov_b32 v216, v208
    v_mov_b32 v217, v208
    v_mov_b32 v218, v208
    v_mov_b32 v219, v208
    v_mov_b32 v220, v208
    v_mov_b32 v221, v208
    v_mov_b32 v222, v208
    v_mov_b32 v223, v208
    s_nop 0
    s_branch L_back7
L_miss6:
    s_nop 7
    v_mov_b32 v208, 0xf149f2ca
    v_mov_b32 v209, v208
    v_mov_b32 v210, v208
    v_mov_b32 v211, v208
    v_mov_b32 v212, v208
    v_mov_b32 v213, v208
    v_mov_b32 v214, v208
    v_mov_b32 v215, v208
    v_mov_b32 v216, v208
    v_mov_b32 v217, v208
    v_mov_b32 v218, v208
    v_mov_b32 v219, v208
    v_mov_b32 v220, v208
    v_mov_b32 v221, v208
    v_mov_b32 v222, v208
    v_mov_b32 v223, v208
    s_nop 0
    s_branch L_back6
L_miss5:
    s_nop 7
    v_mov_b32 v208, 0xf149f2ca
    v_mov_b32 v209, v208
    v_mov_b32 v210, v208
    v_mov_b32 v211, v208
    v_mov_b32 v212, v208
    v_mov_b32 v213, v208
    v_mov_b32 v214, v208
    v_mov_b32 v215, v208
    v_mov_b32 v216, v208
    v_mov_b32 v217, v208
    v_mov_b32 v218, v208
    v_mov_b32 v219, v208
    v_mov_b32 v220, v208
    v_mov_b32 v221, v208
    v_mov_b32 v222, v208
    v_mov_b32 v223, v208
    s_nop 0
    s_branch L_back5
L_miss4:
    s_nop 7
    v_mov_b32 v208, 0xf149f2ca
    v_mov_b32 v209, v208
    v_mov_b32 v210, v208
    v_mov_b32 v211, v208
    v_mov_b32 v212, v208
    v_mov_b32 v213, v208
    v_mov_b32 v214, v208
    v_mov_b32 v215, v208
    v_mov_b32 v216, v208
    v_mov_b32 v217, v208
    v_mov_b32 v218, v208
    v_mov_b32 v219, v208
    v_mov_b32 v220, v208
    v_mov_b32 v221, v208
    v_mov_b32 v222, v208
    v_mov_b32 v223, v208
    s_nop 0
    s_branch L_back4
L_miss3:
    s_nop 7
    v_mov_b32 v208, 0xf149f2ca
    v_mov_b32 v209, v208
    v_mov_b32 v210, v208
    v_mov_b32 v211, v208
    v_mov_b32 v212, v208
    v_mov_b32 v213, v208
    v_mov_b32 v214, v208
    v_mov_b32 v215, v208
    v_mov_b32 v216, v208
    v_mov_b32 v217, v208
    v_mov_b32 v218, v208
    v_mov_b32 v219, v208
    v_mov_b32 v220, v208
    v_mov_b32 v221, v208
    v_mov_b32 v222, v208
    v_mov_b32 v223, v208
    s_nop 0
    s_branch L_back3
L_miss2:
    s_nop 7
    v_mov_b32 v208, 0xf149f2ca
    v_mov_b32 v209, v208
    v_mov_b32 v210, v208
    v_mov_b32 v211, v208
    v_mov_b32 v212, v208
    v_mov_b32 v213, v208
    v_mov_b32 v214, v208
    v_mov_b32 v215, v208
    v_mov_b32 v216, v208
    v_mov_b32 v217, v208
    v_mov_b32 v218, v208
    v_mov_b32 v219, v208
    v_mov_b32 v220, v208
    v_mov_b32 v221, v208
    v_mov_b32 v222, v208
    v_mov_b32 v223, v208
    s_nop 0
    s_branch L_back2
L_miss1:
    s_nop 7
    v_mov_b32 v208, 0xf149f2ca
    v_mov_b32 v209, v208
    v_mov_b32 v210, v208
    v_mov_b32 v211, v208
    v_mov_b32 v212, v208
    v_mov_b32 v213, v208
    v_mov_b32 v214, v208
    v_mov_b32 v215, v208
    v_mov_b32 v216, v208
    v_mov_b32 v217, v208
    v_mov_b32 v218, v208
    v_mov_b32 v219, v208
    v_mov_b32 v220, v208
    v_mov_b32 v221, v208
    v_mov_b32 v222, v208
    v_mov_b32 v223, v208
    s_nop 0
    s_branch L_back1
L_miss0:
    s_nop 7
    v_mov_b32 v208, 0xf149f2ca
    v_mov_b32 v209, v208
    v_mov_b32 v210, v208
    v_mov_b32 v211, v208
    v_mov_b32 v212, v208
    v_mov_b32 v213, v208
    v_mov_b32 v214, v208
    v_mov_b32 v215, v208
    v_mov_b32 v216, v208
    v_mov_b32 v217, v208
    v_mov_b32 v218, v208
    v_mov_b32 v219, v208
    v_mov_b32 v220, v208
    v_mov_b32 v221, v208
    v_mov_b32 v222, v208
    v_mov_b32 v223, v208
    s_nop 0
    s_branch L_back0
L_first:
    v_mov_b32 v13, 0xf149f2ca
    v_cndmask_b32 v192, v13, v192, s[64:65]
    v_cndmask_b32 v193, v13, v193, s[66:67]
    v_cndmask_b32 v194, v13, v194, s[68:69]
    v_cndmask_b32 v195, v13, v195, s[70:71]
    v_cndmask_b32 v196, v13, v196, s[72:73]
    v_cndmask_b32 v197, v13, v197, s[74:75]
    v_cndmask_b32 v198, v13, v198, s[76:77]
    v_cndmask_b32 v199, v13, v199, s[78:79]
    v_cndmask_b32 v200, v13, v200, s[80:81]
    v_cndmask_b32 v201, v13, v201, s[82:83]
    v_cndmask_b32 v202, v13, v202, s[84:85]
    v_cndmask_b32 v203, v13, v203, s[86:87]
    v_cndmask_b32 v204, v13, v204, s[88:89]
    v_cndmask_b32 v205, v13, v205, s[90:91]
    v_cndmask_b32 v206, v13, v206, s[92:93]
    v_cndmask_b32 v207, v13, v207, s[94:95]
    s_branch L_firstback
L_fb:
    s_mov_b32 s42, 0x40000
    v_mov_b32 v9, 0xf149f2ca
    v_mov_b32 v10, v9
    v_mov_b32 v13, v9
    s_mov_b32 s57, 0
L_fba:
    s_add_u32 s55, s63, s57
    s_cmp_lt_u32 s55, 8
    s_cbranch_scc1 L_fba_next
    s_lshl_b32 s55, s57, 12
    s_add_u32 s55, s55, s62
    buffer_load_dwordx4 v[60:63], v5, s[40:43], s55 offen sc1
    s_waitcnt vmcnt(0)
    v_mfma_f32_32x32x16_bf16 v[80:95], v[60:63], v[248:251], 0
    s_nop 15
    s_cmp_lg_u32 s57, 0
    s_cbranch_scc1 L_fba_n0
    v_cndmask_b32 v80, v80, v13, s[64:65]
    v_cndmask_b32 v81, v81, v13, s[66:67]
    v_cndmask_b32 v82, v82, v13, s[68:69]
    v_cndmask_b32 v83, v83, v13, s[70:71]
    v_cndmask_b32 v84, v84, v13, s[72:73]
    v_cndmask_b32 v85, v85, v13, s[74:75]
    v_cndmask_b32 v86, v86, v13, s[76:77]
    v_cndmask_b32 v87, v87, v13, s[78:79]
    v_cndmask_b32 v88, v88, v13, s[80:81]
    v_cndmask_b32 v89, v89, v13, s[82:83]
    v_cndmask_b32 v90, v90, v13, s[84:85]
    v_cndmask_b32 v91, v91, v13, s[86:87]
    v_cndmask_b32 v92, v92, v13, s[88:89]
    v_cndmask_b32 v93, v93, v13, s[90:91]
    v_cndmask_b32 v94, v94, v13, s[92:93]
    v_cndmask_b32 v95, v95, v13, s[94:95]
L_fba_n0:
    s_cmp_lg_u32 s57, 8
    s_cbranch_scc1 L_fba_n8
    v_cndmask_b32 v80, v13, v80, s[64:65]
    v_cndmask_b32 v81, v13, v81, s[66:67]
    v_cndmask_b32 v82, v13, v82, s[68:69]
    v_cndmask_b32 v83, v13, v83, s[70:71]
    v_cndmask_b32 v84, v13, v84, s[72:73]
    v_cndmask_b32 v85, v13, v85, s[74:75]
    v_cndmask_b32 v86, v13, v86, s[76:77]
    v_cndmask_b32 v87, v13, v87, s[78:79]
    v_cndmask_b32 v88, v13, v88, s[80:81]
    v_cndmask_b32 v89, v13, v89, s[82:83]
    v_cndmask_b32 v90, v13, v90, s[84:85]
    v_cndmask_b32 v91, v13, v91, s[86:87]
    v_cndmask_b32 v92, v13, v92, s[88:89]
    v_cndmask_b32 v93, v13, v93, s[90:91]
    v_cndmask_b32 v94, v13, v94, s[92:93]
    v_cndmask_b32 v95, v13, v95, s[94:95]
L_fba_n8:
    v_max3_f32 v9, v9, v80, v81
    v_max3_f32 v10, v10, v82, v83
    v_max3_f32 v9, v9, v84, v85
    v_max3_f32 v10, v10, v86, v87
    v_max3_f32 v9, v9, v88, v89
    v_max3_f32 v10, v10, v90, v91
    v_max3_f32 v9, v9, v92, v93
    v_max3_f32 v10, v10, v94, v95
L_fba_next:
    s_add_u32 s57, s57, 1
    s_cmp_lt_u32 s57, 9
    s_cbranch_scc1 L_fba
    v_max_f32 v9, v9, v10
    s_nop 0
    v_mov_b32 v10, v9
    s_nop 1
    v_permlane32_swap_b32 v9, v10
    s_nop 1
    v_max_f32 v9, v9, v10
    v_sub_f32 v96, 0, v9
    v_mov_b32 v97, v96
    v_mov_b32 v98, v96
    v_mov_b32 v99, v96
    v_mov_b32 v100, v96
    v_mov_b32 v101, v96
    v_mov_b32 v102, v96
    v_mov_b32 v103, v96
    v_mov_b32 v104, v96
    v_mov_b32 v105, v96
    v_mov_b32 v106, v96
    v_mov_b32 v107, v96
    v_mov_b32 v108, v96
    v_mov_b32 v109, v96
    v_mov_b32 v110, v96
    v_mov_b32 v111, v96
    v_mov_b32 v208, 0
    v_mov_b32 v209, 0
    v_mov_b32 v210, 0
    v_mov_b32 v211, 0
    v_mov_b32 v212, 0
    v_mov_b32 v213, 0
    v_mov_b32 v214, 0
    v_mov_b32 v215, 0
    v_mov_b32 v216, 0
    v_mov_b32 v217, 0
    v_mov_b32 v218, 0
    v_mov_b32 v219, 0
    v_mov_b32 v220, 0
    v_mov_b32 v221, 0
    v_mov_b32 v222, 0
    v_mov_b32 v223, 0
    s_mov_b32 s57, 0
L_fbb:
    s_add_u32 s55, s63, s57
    s_cmp_lt_u32 s55, 8
    s_cbranch_scc1 L_fbb_next
    s_lshl_b32 s55, s57, 12
    s_add_u32 s55, s55, s62
    buffer_load_dwordx4 v[60:63], v5, s[40:43], s55 offen sc1
    s_waitcnt vmcnt(0)
    v_mfma_f32_32x32x16_bf16 v[80:95], v[60:63], v[248:251], v[96:111]
    s_nop 15
    s_cmp_lg_u32 s57, 0
    s_cbranch_scc1 L_fbb_n0
    v_cndmask_b32 v80, v80, v13, s[64:65]
    v_cndmask_b32 v81, v81, v13, s[66:67]
    v_cndmask_b32 v82, v82, v13, s[68:69]
    v_cndmask_b32 v83, v83, v13, s[70:71]
    v_cndmask_b32 v84, v84, v13, s[72:73]
    v_cndmask_b32 v85, v85, v13, s[74:75]
    v_cndmask_b32 v86, v86, v13, s[76:77]
    v_cndmask_b32 v87, v87, v13, s[78:79]
    v_cndmask_b32 v88, v88, v13, s[80:81]
    v_cndmask_b32 v89, v89, v13, s[82:83]
    v_cndmask_b32 v90, v90, v13, s[84:85]
    v_cndmask_b32 v91, v91, v13, s[86:87]
    v_cndmask_b32 v92, v92, v13, s[88:89]
    v_cndmask_b32 v93, v93, v13, s[90:91]
    v_cndmask_b32 v94, v94, v13, s[92:93]
    v_cndmask_b32 v95, v95, v13, s[94:95]
L_fbb_n0:
    s_cmp_lg_u32 s57, 8
    s_cbranch_scc1 L_fbb_n8
    v_cndmask_b32 v80, v13, v80, s[64:65]
    v_cndmask_b32 v81, v13, v81, s[66:67]
    v_cndmask_b32 v82, v13, v82, s[68:69]
    v_cndmask_b32 v83, v13, v83, s[70:71]
    v_cndmask_b32 v84, v13, v84, s[72:73]
    v_cndmask_b32 v85, v13, v85, s[74:75]
    v_cndmask_b32 v86, v13, v86, s[76:77]
    v_cndmask_b32 v87, v13, v87, s[78:79]
    v_cndmask_b32 v88, v13, v88, s[80:81]
    v_cndmask_b32 v89, v13, v89, s[82:83]
    v_cndmask_b32 v90, v13, v90, s[84:85]
    v_cndmask_b32 v91, v13, v91, s[86:87]
    v_cndmask_b32 v92, v13, v92, s[88:89]
    v_cndmask_b32 v93, v13, v93, s[90:91]
    v_cndmask_b32 v94, v13, v94, s[92:93]
    v_cndmask_b32 v95, v13, v95, s[94:95]
L_fbb_n8:
    v_exp_f32 v80, v80
    v_exp_f32 v81, v81
    v_exp_f32 v82, v82
    v_exp_f32 v83, v83
    v_cvt_pk_bf16_f32 v80, v80, v81
    v_exp_f32 v84, v84
    v_exp_f32 v85, v85
    v_cvt_pk_bf16_f32 v81, v82, v83
    v_exp_f32 v86, v86
    v_exp_f32 v87, v87
    v_cvt_pk_bf16_f32 v82, v84, v85
    v_exp_f32 v88, v88
    v_exp_f32 v89, v89
    v_cvt_pk_bf16_f32 v83, v86, v87
    v_exp_f32 v90, v90
    v_exp_f32 v91, v91
    v_cvt_pk_bf16_f32 v84, v88, v89
    v_exp_f32 v92, v92
    v_exp_f32 v93, v93
    v_cvt_pk_bf16_f32 v85, v90, v91
    v_exp_f32 v94, v94
    v_exp_f32 v95, v95
    v_cvt_pk_bf16_f32 v86, v92, v93
    s_nop 0
    v_cvt_pk_bf16_f32 v87, v94, v95
    s_lshl_b32 s55, s57, 12
    v_add_u32 v14, s55, v6
    s_cmp_lg_u32 s57, 7
    s_cbranch_scc1 L_fbb_v7
    v_mov_b32 v14, v7
L_fbb_v7:
    s_cmp_lg_u32 s57, 8
    s_cbranch_scc1 L_fbb_v8
    v_mov_b32 v14, v8
L_fbb_v8:
    s_mov_b64 exec, s[96:97]
    ds_read_b128 v[224:227], v14
    ds_read_b128 v[228:231], v14 offset:512
    s_mov_b64 exec, -1
    s_waitcnt lgkmcnt(0)
    v_mfma_f32_32x32x16_bf16 v[208:223], v[224:227], v[80:83], v[208:223]
    v_mfma_f32_32x32x16_bf16 v[208:223], v[228:231], v[84:87], v[208:223]
    s_nop 15
L_fbb_next:
    s_add_u32 s57, s57, 1
    s_cmp_lt_u32 s57, 9
    s_cbranch_scc1 L_fbb
    v_rcp_f32 v10, v216
    s_nop 0
    s_branch L_norm
L_codeend:
    .fill 256, 4, 0xBF800000
.section .rodata,"a"
.p2align 6
.amdhsa_kernel concat_heads__spectral_fnet__sliding_block__prompt_kernel
  .amdhsa_next_free_vgpr 256
  .amdhsa_next_free_sgpr 102
  .amdhsa_accum_offset 256
  .amdhsa_group_segment_fixed_size 0
  .amdhsa_kernarg_size 88
  .amdhsa_user_sgpr_count 2
  .amdhsa_user_sgpr_kernarg_segment_ptr 1
  .amdhsa_system_sgpr_workgroup_id_x 1
.end_amdhsa_kernel
```
